```python
import torch

def _softmax(x, axis=-1):
    return torch.softmax(x, dim=axis)
def _gelu(x):
    return torch.nn.functional.gelu(x, approximate="tanh")
def _silu(x):
    return torch.nn.functional.silu(x)
def _sigmoid(x):
    return torch.sigmoid(x)
def _layernorm(x, axis=-1, eps=1e-5):
    m = x.mean(dim=axis, keepdim=True)
    v = x.var(dim=axis, keepdim=True, unbiased=False)
    return (x - m) / torch.sqrt(v + eps)
def _scatter_add(tgt, idx, src, axis=0):
    return tgt.clone().index_add_(axis, idx, src)
def _segment_sum(src, seg, n):
    out = torch.zeros((n,) + src.shape[1:], dtype=src.dtype)
    return out.index_add_(0, seg, src)
def _pad(x, pw):
    flat = tuple(v for pair in reversed(pw) for v in pair)
    return torch.nn.functional.pad(x, flat)

kernel_name = 'concat_heads__linear_attn_block__sliding_local_dilated__prompt'

def setup_inputs():

    _w = (lambda a: (lambda t: t.to(torch.bfloat16) if t.is_floating_point() else t)(torch.as_tensor(a)))
    def _A_setup():
        B, S, D = 1, 2048, 512
        return {
            "x": _w((lambda *s: torch.randn(*s, dtype=torch.bfloat16) * 0.05)(B, S, D)),
            "wqkv": _w((lambda *s: torch.randn(*s, dtype=torch.bfloat16) * 1.6)(D, 3 * D)),
            "wo": _w((lambda *s: torch.randn(*s, dtype=torch.bfloat16) * 0.8)(D, D)),
        }
    _A_in = _A_setup()

    def _B_setup():
        B, S, D = 1, 2048, 512
        return {
            "x": _w((lambda *s: torch.randn(*s, dtype=torch.bfloat16) * 0.2)(B, S, D)),
            "wqkv": _w((lambda *s: torch.randn(*s, dtype=torch.bfloat16) * 0.2)(D, 3 * D)),
            "wo": _w((lambda *s: torch.randn(*s, dtype=torch.bfloat16) * 0.05)(D, D)),
        }
    _B_in = _B_setup()

    return {
        "A_x": _A_in["x"],
        "A_wqkv": _A_in["wqkv"],
        "A_wo": _A_in["wo"],
        "B_x": _B_in["x"],
        "B_wqkv": _B_in["wqkv"],
        "B_wo": _B_in["wo"],
    }

def reference(A_x, A_wqkv, A_wo, B_x, B_wqkv, B_wo):
    def _A_ref(x, wqkv, wo):
        B, S, D = x.shape
        H = 32; Dh = D // H
        qkv = (lambda x, *d: x.permute(*d))((x @ wqkv).reshape(B, S, 3, H, Dh), 2, 0, 3, 1, 4)
        q, k, v = qkv[0], qkv[1], qkv[2]
        phi = lambda t: torch.where(t > 0, t + 1, torch.exp(t)) + 1e-6
        pq, pk = phi(q), phi(k)
        kv = torch.einsum("bhsd,bhse->bhde", pk, v)
        z = torch.einsum("bhsd->bhd", pk)
        num = torch.einsum("bhqd,bhde->bhqe", pq, kv)
        den = torch.einsum("bhqd,bhd->bhq", pq, z)[..., None] + 1e-6
        o = num / den
        return (lambda x, *d: x.permute(*d))(o, 0, 2, 1, 3).reshape(B, S, D) @ wo

    def _B_ref(x, wqkv, wo):
        B, S, D = x.shape
        H = 32; Dh = D // H
        W, dil = 8, 2
        qkv = (lambda x, *d: x.permute(*d))((x @ wqkv).reshape(B, S, 3, H, Dh), 2, 0, 3, 1, 4)
        q, k, v = qkv[0], qkv[1], qkv[2]
        scale = Dh ** -0.5
        pos = torch.arange(S)
        off = torch.arange(W) * dil
        idx = pos[:, None] - off[None, :]
        mask = idx >= 0
        idx_c = torch.where(mask, idx, 0).reshape(-1)
        kg = k[:, :, idx_c, :].reshape(B, H, S, W, Dh)
        vg = v[:, :, idx_c, :].reshape(B, H, S, W, Dh)
        logits = torch.einsum("bhsd,bhswd->bhsw", q, kg) * scale
        logits = torch.where(mask[None, None, :, :], logits, -1e9)
        attn = _softmax(logits, axis=-1)
        o = torch.einsum("bhsw,bhswd->bhsd", attn, vg)
        return (lambda x, *d: x.permute(*d))(o, 0, 2, 1, 3).reshape(B, S, D) @ wo

    a = _A_ref(A_x, A_wqkv, A_wo)
    b = _B_ref(B_x, B_wqkv, B_wo)
    return torch.concatenate([a, b], axis=-1)
```

```asm
; @launch grid=(256,1,1) block=(256,1,1) lds=163840
.amdgcn_target "amdgcn-amd-amdhsa--gfx950"
.text
.globl concat_heads__linear_attn_block__sliding_local_dilated__prompt_kernel
.p2align 8
.type concat_heads__linear_attn_block__sliding_local_dilated__prompt_kernel,@function
concat_heads__linear_attn_block__sliding_local_dilated__prompt_kernel:
s_cmp_ge_u32 s2, 256
s_cbranch_scc0 L_go
s_endpgm
L_go:
s_load_dwordx16 s[8:23], s[0:1], 0
s_load_dwordx2 s[24:25], s[0:1], 64
v_and_b32 v1, 63, v0
v_lshrrev_b32 v2, 6, v0
s_lshr_b32 s26, s2, 2
v_readfirstlane_b32 s29, v2
s_and_b32 s26, s26, 1
s_and_b32 s52, s2, 3
s_lshr_b32 s53, s2, 3
s_lshr_b32 s30, s53, 3
s_lshl_b32 s54, s52, 2
s_add_u32 s30, s30, s54
s_and_b32 s31, s53, 7
s_mov_b32 s27, s30
s_mov_b32 s28, s31
v_lshrrev_b32 v16, 3, v1
s_lshl_b32 s52, s29, 4
v_add_u32 v17, s52, v16
v_mul_u32_u24 v17, 3072, v17
v_lshrrev_b32 v18, 4, v1
v_and_b32 v19, 1, v18
v_lshlrev_b32 v19, 1, v19
v_and_b32 v20, 7, v1
v_xor_b32 v19, v19, v20
v_lshlrev_b32 v19, 4, v19
s_lshl_b32 s52, s28, 7
v_add3_u32 v7, v17, v19, s52
v_xor_b32 v8, 64, v7
v_add_u32 v8, 23552, v8
s_cmp_eq_u32 s26, 0
s_cbranch_scc0 L_B
s_mov_b32 s34, 0x200000
s_mov_b32 s35, 0x20000
s_mov_b32 s38, 0x180000
s_mov_b32 s39, 0x20000
s_lshl_b32 s71, s29, 11
s_lshl_b32 s72, s29, 12
s_add_u32 s72, s72, 0x18000
s_xor_b32 s57, s27, s28
s_and_b32 s57, s57, 1
s_lshl_b32 s57, s57, 2
s_and_b32 s56, s2, 3
s_add_u32 s57, s57, s56
s_and_b32 s57, s57, 7
s_lshl_b32 s65, s57, 7
s_mul_i32 s64, s57, 0x30000
s_lshl_b32 s52, s27, 7
s_lshl_b32 s53, s29, 5
s_add_u32 s52, s52, s53
v_add_u32 v2, s52, v16
v_lshlrev_b32 v2, 10, v2
v_xor_b32 v19, v20, v18
v_lshl_add_u32 v2, v19, 4, v2
v_xor_b32 v3, 64, v2
v_add_u32 v4, 14336, v2
v_add_u32 v5, 21504, v3
v_add_u32 v3, 7168, v3
v_and_b32 v19, 1, v18
v_lshlrev_b32 v19, 2, v19
v_xor_b32 v19, v19, v20
v_lshlrev_b32 v19, 4, v19
s_lshl_b32 s52, s28, 7
v_add3_u32 v7, v17, v19, s52
v_add_u32 v8, 23552, v7
s_waitcnt lgkmcnt(0)
s_mov_b32 s32, s8
s_mov_b32 s33, s9
s_mov_b32 s36, s10
s_mov_b32 s37, s11
s_add_u32 m0, s72, 0x0
s_nop 0
buffer_load_dwordx4 v2, s[32:35], s65 offen lds
buffer_load_dwordx4 v3, s[32:35], s65 offen offset:1024 lds
buffer_load_dwordx4 v4, s[32:35], s65 offen offset:2048 lds
buffer_load_dwordx4 v5, s[32:35], s65 offen offset:3072 lds
s_add_u32 s65, s65, 128
s_and_b32 s65, s65, 1023
s_add_u32 m0, s71, 0xc00
s_nop 0
buffer_load_dwordx4 v7, s[36:39], s64 offen offset:1024 lds
buffer_load_dwordx4 v8, s[36:39], s64 offen offset:2048 lds
s_add_u32 m0, s71, 0x2800
s_nop 0
buffer_load_dwordx4 v7, s[36:39], s64 offen offset:2048 lds
buffer_load_dwordx4 v8, s[36:39], s64 offen offset:3072 lds
s_add_u32 s64, s64, 0x30000
s_cmp_eq_u32 s64, 0x180000
s_cselect_b32 s64, 0, s64
s_mov_b32 s44, s24
s_mov_b32 s45, s25
s_mov_b32 s46, 0x800000
s_mov_b32 s47, 0x20000
s_cmp_ge_u32 s2, 16
s_cbranch_scc1 L_nozero_1
v_mov_b32 v24, 0
v_mov_b32 v25, 0
v_mov_b32 v26, 0
v_mov_b32 v27, 0
v_lshlrev_b32 v22, 4, v1
s_lshl_b32 s52, s2, 12
s_lshl_b32 s53, s29, 10
s_add_u32 s52, s52, s53
buffer_store_dwordx4 v[24:27], v22, s[44:47], s52 offen sc1
L_nozero_1:
v_lshrrev_b32 v21, 5, v1
s_add_u32 m0, s72, 0x4000
s_nop 0
buffer_load_dwordx4 v2, s[32:35], s65 offen lds
v_lshlrev_b32 v10, 10, v21
v_bfe_u32 v22, v1, 2, 2
v_lshl_add_u32 v10, v22, 7, v10
v_bfe_u32 v22, v1, 4, 1
buffer_load_dwordx4 v3, s[32:35], s65 offen offset:1024 lds
v_lshlrev_b32 v23, 5, v22
v_and_b32 v22, 3, v1
v_lshl_add_u32 v23, v22, 3, v23
s_and_b32 s62, s29, 1
s_lshl_b32 s62, s62, 6
buffer_load_dwordx4 v4, s[32:35], s65 offen offset:2048 lds
v_add_u32 v23, s62, v23
v_bfe_u32 v22, v1, 3, 1
v_lshlrev_b32 v22, 6, v22
v_xor_b32 v23, v23, v22
v_add_u32 v10, v10, v23
buffer_load_dwordx4 v5, s[32:35], s65 offen offset:3072 lds
s_add_u32 s65, s65, 128
s_and_b32 s65, s65, 1023
v_add_u32 v12, 49152, v10
v_and_b32 v22, 31, v1
v_lshlrev_b32 v23, 7, v22
v_bfe_u32 v22, v1, 1, 3
s_add_u32 m0, s71, 0x4c00
s_nop 0
buffer_load_dwordx4 v7, s[36:39], s64 offen offset:1024 lds
v_xor_b32 v22, v22, v21
v_lshl_add_u32 v23, v22, 4, v23
s_lshr_b32 s62, s29, 1
s_lshl_b32 s62, s62, 13
s_add_u32 s62, s62, 0x18000
v_add_u32 v72, s62, v23
v_xor_b32 v73, 32, v72
buffer_load_dwordx4 v8, s[36:39], s64 offen offset:2048 lds
v_xor_b32 v74, 64, v72
v_xor_b32 v75, 96, v72
s_mov_b32 s62, 0x358637bd
v_mov_b32 v56, s62
s_add_u32 m0, s71, 0x6800
s_nop 0
buffer_load_dwordx4 v7, s[36:39], s64 offen offset:2048 lds
v_mov_b32 v57, s62
v_mov_b32 v58, s62
v_mov_b32 v59, s62
v_mov_b32 v60, s62
v_mov_b32 v61, s62
buffer_load_dwordx4 v8, s[36:39], s64 offen offset:3072 lds
s_add_u32 s64, s64, 0x30000
s_cmp_eq_u32 s64, 0x180000
s_cselect_b32 s64, 0, s64
v_mov_b32 v62, s62
v_mov_b32 v63, s62
v_mov_b32 v64, s62
v_mov_b32 v65, s62
s_add_u32 m0, s72, 0x8000
s_nop 0
buffer_load_dwordx4 v2, s[32:35], s65 offen lds
v_mov_b32 v66, s62
v_mov_b32 v67, s62
v_mov_b32 v68, s62
v_mov_b32 v69, s62
v_mov_b32 v70, s62
buffer_load_dwordx4 v3, s[32:35], s65 offen offset:1024 lds
v_mov_b32 v71, s62
v_lshrrev_b32 v180, 3, v1
s_lshl_b32 s62, s29, 7
v_add_u32 v180, s62, v180
buffer_load_dwordx4 v4, s[32:35], s65 offen offset:2048 lds
v_lshlrev_b32 v180, 10, v180
v_bfe_u32 v181, v1, 4, 1
v_lshlrev_b32 v181, 2, v181
v_and_b32 v182, 7, v1
v_xor_b32 v181, v181, v182
buffer_load_dwordx4 v5, s[32:35], s65 offen offset:3072 lds
s_add_u32 s65, s65, 128
s_and_b32 s65, s65, 1023
v_lshlrev_b32 v181, 4, v181
s_lshl_b32 s62, s31, 7
v_add3_u32 v52, v180, v181, s62
v_add_u32 v53, 7168, v52
v_add_u32 v54, 14336, v52
v_add_u32 v55, 21504, v52
s_lshl_b32 s70, s29, 14
s_add_u32 s70, s70, 0x18000
s_mov_b32 s40, s12
s_mov_b32 s41, s13
s_mov_b32 s42, 0x80000
s_mov_b32 s43, 0x20000
s_waitcnt vmcnt(12)
s_barrier
ds_read_b128 a[0:3], v72 offset:0
ds_read_b128 a[4:7], v72 offset:4096
ds_read_b128 a[8:11], v73 offset:0
ds_read_b128 a[12:15], v73 offset:4096
ds_read_b128 a[16:19], v74 offset:0
ds_read_b128 a[20:23], v74 offset:4096
ds_read_b128 a[24:27], v75 offset:0
ds_read_b128 a[28:31], v75 offset:4096
ds_read_b64_tr_b16 v[20:21], v10 offset:4096
ds_read_b64_tr_b16 v[22:23], v10 offset:4608
ds_read_b64_tr_b16 v[24:25], v10 offset:12288
ds_read_b64_tr_b16 v[26:27], v10 offset:12800
ds_read_b64_tr_b16 v[28:29], v10 offset:6144
ds_read_b64_tr_b16 v[30:31], v10 offset:6656
ds_read_b64_tr_b16 v[32:33], v10 offset:14336
ds_read_b64_tr_b16 v[34:35], v10 offset:14848
s_waitcnt lgkmcnt(0)
v_mfma_f32_32x32x16_bf16 v[84:99], a[0:3], v[20:23], v[56:71]
ds_read_b64_tr_b16 v[36:37], v10 offset:8192
ds_read_b64_tr_b16 v[38:39], v10 offset:8704
s_add_u32 m0, s71, 0x8c00
v_mfma_f32_32x32x16_bf16 v[100:115], a[4:7], v[20:23], v[56:71]
ds_read_b64_tr_b16 v[40:41], v10 offset:16384
ds_read_b64_tr_b16 v[42:43], v10 offset:16896
buffer_load_dwordx4 v7, s[36:39], s64 offen offset:1024 lds
v_mfma_f32_32x32x16_bf16 v[116:131], a[0:3], v[24:27], 0
ds_read_b64_tr_b16 v[44:45], v10 offset:10240
buffer_load_dwordx4 v8, s[36:39], s64 offen offset:2048 lds
v_mfma_f32_32x32x16_bf16 v[132:147], a[4:7], v[24:27], 0
ds_read_b64_tr_b16 v[46:47], v10 offset:10752
ds_read_b64_tr_b16 v[48:49], v10 offset:18432
s_add_u32 m0, s71, 0xa800
v_mfma_f32_32x32x16_bf16 v[84:99], a[8:11], v[28:31], v[84:99]
ds_read_b64_tr_b16 v[50:51], v10 offset:18944
buffer_load_dwordx4 v7, s[36:39], s64 offen offset:2048 lds
v_mfma_f32_32x32x16_bf16 v[100:115], a[12:15], v[28:31], v[100:115]
buffer_load_dwordx4 v8, s[36:39], s64 offen offset:3072 lds
v_mfma_f32_32x32x16_bf16 v[116:131], a[8:11], v[32:35], v[116:131]
s_add_u32 s64, s64, 0x30000
v_mfma_f32_32x32x16_bf16 v[132:147], a[12:15], v[32:35], v[132:147]
s_cmp_eq_u32 s64, 0x180000
s_cselect_b32 s64, 0, s64
s_waitcnt lgkmcnt(0)
s_waitcnt vmcnt(8)
s_barrier
s_cmp_ge_u32 s2, 16
s_cbranch_scc1 L_nosigz_2
s_cmp_eq_u32 s29, 0
s_cbranch_scc0 L_nosigz_2
v_mov_b32 v244, 0
v_mov_b32 v245, 1
s_mov_b64 exec, 1
global_atomic_add v244, v245, s[22:23] sc1
s_mov_b64 exec, -1
L_nosigz_2:
v_mfma_f32_32x32x16_bf16 v[84:99], a[16:19], v[36:39], v[84:99]
ds_read_b128 a[32:35], v72 offset:16384
ds_read_b128 a[36:39], v72 offset:20480
ds_read_b128 a[40:43], v73 offset:16384
ds_read_b128 a[44:47], v73 offset:20480
s_add_u32 m0, s72, 0xc000
v_mfma_f32_32x32x16_bf16 v[100:115], a[20:23], v[36:39], v[100:115]
ds_read_b128 a[48:51], v74 offset:16384
ds_read_b128 a[52:55], v74 offset:20480
ds_read_b128 a[56:59], v75 offset:16384
buffer_load_dwordx4 v2, s[32:35], s65 offen lds
buffer_load_dwordx4 v3, s[32:35], s65 offen offset:1024 lds
v_mfma_f32_32x32x16_bf16 v[116:131], a[16:19], v[40:43], v[116:131]
ds_read_b128 a[60:63], v75 offset:20480
ds_read_b64_tr_b16 v[20:21], v10 offset:20480
ds_read_b64_tr_b16 v[22:23], v10 offset:20992
buffer_load_dwordx4 v4, s[32:35], s65 offen offset:2048 lds
buffer_load_dwordx4 v5, s[32:35], s65 offen offset:3072 lds
v_mfma_f32_32x32x16_bf16 v[132:147], a[20:23], v[40:43], v[132:147]
ds_read_b64_tr_b16 v[24:25], v10 offset:28672
ds_read_b64_tr_b16 v[26:27], v10 offset:29184
ds_read_b64_tr_b16 v[28:29], v10 offset:22528
s_add_u32 s65, s65, 128
s_and_b32 s65, s65, 1023
v_mfma_f32_32x32x16_bf16 v[84:99], a[24:27], v[44:47], v[84:99]
ds_read_b64_tr_b16 v[30:31], v10 offset:23040
ds_read_b64_tr_b16 v[32:33], v10 offset:30720
ds_read_b64_tr_b16 v[34:35], v10 offset:31232
s_add_u32 m0, s71, 0xcc00
s_nop 0
buffer_load_dwordx4 v7, s[36:39], s64 offen offset:1024 lds
v_mfma_f32_32x32x16_bf16 v[100:115], a[28:31], v[44:47], v[100:115]
buffer_load_dwordx4 v8, s[36:39], s64 offen offset:2048 lds
s_add_u32 m0, s71, 0xe800
s_nop 0
buffer_load_dwordx4 v7, s[36:39], s64 offen offset:2048 lds
v_mfma_f32_32x32x16_bf16 v[116:131], a[24:27], v[48:51], v[116:131]
buffer_load_dwordx4 v8, s[36:39], s64 offen offset:3072 lds
s_add_u32 s64, s64, 0x30000
v_mfma_f32_32x32x16_bf16 v[132:147], a[28:31], v[48:51], v[132:147]
s_cmp_eq_u32 s64, 0x180000
s_cselect_b32 s64, 0, s64
s_waitcnt lgkmcnt(0)
v_mfma_f32_32x32x16_bf16 v[84:99], a[32:35], v[20:23], v[84:99]
ds_read_b64_tr_b16 v[36:37], v10 offset:24576
ds_read_b64_tr_b16 v[38:39], v10 offset:25088
s_add_u32 m0, s71, 0x10c00
v_mfma_f32_32x32x16_bf16 v[100:115], a[36:39], v[20:23], v[100:115]
ds_read_b64_tr_b16 v[40:41], v10 offset:32768
ds_read_b64_tr_b16 v[42:43], v10 offset:33280
buffer_load_dwordx4 v7, s[36:39], s64 offen offset:1024 lds
v_mfma_f32_32x32x16_bf16 v[116:131], a[32:35], v[24:27], v[116:131]
ds_read_b64_tr_b16 v[44:45], v10 offset:26624
buffer_load_dwordx4 v8, s[36:39], s64 offen offset:2048 lds
v_mfma_f32_32x32x16_bf16 v[132:147], a[36:39], v[24:27], v[132:147]
ds_read_b64_tr_b16 v[46:47], v10 offset:27136
ds_read_b64_tr_b16 v[48:49], v10 offset:34816
s_add_u32 m0, s71, 0x12800
v_mfma_f32_32x32x16_bf16 v[84:99], a[40:43], v[28:31], v[84:99]
ds_read_b64_tr_b16 v[50:51], v10 offset:35328
buffer_load_dwordx4 v7, s[36:39], s64 offen offset:2048 lds
v_mfma_f32_32x32x16_bf16 v[100:115], a[44:47], v[28:31], v[100:115]
buffer_load_dwordx4 v8, s[36:39], s64 offen offset:3072 lds
v_mfma_f32_32x32x16_bf16 v[116:131], a[40:43], v[32:35], v[116:131]
s_add_u32 s64, s64, 0x30000
v_mfma_f32_32x32x16_bf16 v[132:147], a[44:47], v[32:35], v[132:147]
s_cmp_eq_u32 s64, 0x180000
s_cselect_b32 s64, 0, s64
s_waitcnt lgkmcnt(0)
s_waitcnt vmcnt(12)
s_barrier
v_mfma_f32_32x32x16_bf16 v[84:99], a[48:51], v[36:39], v[84:99]
ds_read_b128 a[64:67], v72 offset:32768
ds_read_b128 a[68:71], v72 offset:36864
ds_read_b128 a[72:75], v73 offset:32768
ds_read_b128 a[76:79], v73 offset:36864
s_add_u32 m0, s72, 0x0
v_mfma_f32_32x32x16_bf16 v[100:115], a[52:55], v[36:39], v[100:115]
ds_read_b128 a[80:83], v74 offset:32768
ds_read_b128 a[84:87], v74 offset:36864
ds_read_b128 a[88:91], v75 offset:32768
buffer_load_dwordx4 v2, s[32:35], s65 offen lds
buffer_load_dwordx4 v3, s[32:35], s65 offen offset:1024 lds
v_mfma_f32_32x32x16_bf16 v[116:131], a[48:51], v[40:43], v[116:131]
ds_read_b128 a[92:95], v75 offset:36864
ds_read_b64_tr_b16 v[20:21], v10 offset:36864
ds_read_b64_tr_b16 v[22:23], v10 offset:37376
buffer_load_dwordx4 v4, s[32:35], s65 offen offset:2048 lds
buffer_load_dwordx4 v5, s[32:35], s65 offen offset:3072 lds
v_mfma_f32_32x32x16_bf16 v[132:147], a[52:55], v[40:43], v[132:147]
ds_read_b64_tr_b16 v[24:25], v10 offset:45056
ds_read_b64_tr_b16 v[26:27], v10 offset:45568
ds_read_b64_tr_b16 v[28:29], v10 offset:38912
s_add_u32 s65, s65, 128
s_and_b32 s65, s65, 1023
v_mfma_f32_32x32x16_bf16 v[84:99], a[56:59], v[44:47], v[84:99]
ds_read_b64_tr_b16 v[30:31], v10 offset:39424
ds_read_b64_tr_b16 v[32:33], v10 offset:47104
ds_read_b64_tr_b16 v[34:35], v10 offset:47616
s_add_u32 m0, s71, 0xc00
s_nop 0
buffer_load_dwordx4 v7, s[36:39], s64 offen offset:1024 lds
v_mfma_f32_32x32x16_bf16 v[100:115], a[60:63], v[44:47], v[100:115]
buffer_load_dwordx4 v8, s[36:39], s64 offen offset:2048 lds
s_add_u32 m0, s71, 0x2800
s_nop 0
buffer_load_dwordx4 v7, s[36:39], s64 offen offset:2048 lds
v_mfma_f32_32x32x16_bf16 v[116:131], a[56:59], v[48:51], v[116:131]
buffer_load_dwordx4 v8, s[36:39], s64 offen offset:3072 lds
s_add_u32 s64, s64, 0x30000
v_mfma_f32_32x32x16_bf16 v[132:147], a[60:63], v[48:51], v[132:147]
s_cmp_eq_u32 s64, 0x180000
s_cselect_b32 s64, 0, s64
s_waitcnt lgkmcnt(0)
v_mfma_f32_32x32x16_bf16 v[84:99], a[64:67], v[20:23], v[84:99]
ds_read_b64_tr_b16 v[36:37], v10 offset:40960
ds_read_b64_tr_b16 v[38:39], v10 offset:41472
s_add_u32 m0, s72, 0x4000
v_mfma_f32_32x32x16_bf16 v[100:115], a[68:71], v[20:23], v[100:115]
ds_read_b64_tr_b16 v[40:41], v10 offset:49152
ds_read_b64_tr_b16 v[42:43], v10 offset:49664
buffer_load_dwordx4 v2, s[32:35], s65 offen lds
v_mfma_f32_32x32x16_bf16 v[116:131], a[64:67], v[24:27], v[116:131]
ds_read_b64_tr_b16 v[44:45], v10 offset:43008
buffer_load_dwordx4 v3, s[32:35], s65 offen offset:1024 lds
v_mfma_f32_32x32x16_bf16 v[132:147], a[68:71], v[24:27], v[132:147]
ds_read_b64_tr_b16 v[46:47], v10 offset:43520
ds_read_b64_tr_b16 v[48:49], v10 offset:51200
buffer_load_dwordx4 v4, s[32:35], s65 offen offset:2048 lds
v_mfma_f32_32x32x16_bf16 v[84:99], a[72:75], v[28:31], v[84:99]
ds_read_b64_tr_b16 v[50:51], v10 offset:51712
buffer_load_dwordx4 v5, s[32:35], s65 offen offset:3072 lds
v_mfma_f32_32x32x16_bf16 v[100:115], a[76:79], v[28:31], v[100:115]
s_add_u32 s65, s65, 128
v_mfma_f32_32x32x16_bf16 v[116:131], a[72:75], v[32:35], v[116:131]
s_and_b32 s65, s65, 1023
v_mfma_f32_32x32x16_bf16 v[132:147], a[76:79], v[32:35], v[132:147]
s_waitcnt lgkmcnt(0)
s_waitcnt vmcnt(16)
s_barrier
v_mfma_f32_32x32x16_bf16 v[84:99], a[80:83], v[36:39], v[84:99]
ds_read_b128 a[96:99], v72 offset:49152
ds_read_b128 a[100:103], v72 offset:53248
ds_read_b128 a[104:107], v73 offset:49152
ds_read_b128 a[108:111], v73 offset:53248
s_add_u32 m0, s71, 0x4c00
v_mfma_f32_32x32x16_bf16 v[100:115], a[84:87], v[36:39], v[100:115]
ds_read_b128 a[112:115], v74 offset:49152
ds_read_b128 a[116:119], v74 offset:53248
ds_read_b128 a[120:123], v75 offset:49152
buffer_load_dwordx4 v7, s[36:39], s64 offen offset:1024 lds
buffer_load_dwordx4 v8, s[36:39], s64 offen offset:2048 lds
v_mfma_f32_32x32x16_bf16 v[116:131], a[80:83], v[40:43], v[116:131]
ds_read_b128 a[124:127], v75 offset:53248
ds_read_b64_tr_b16 v[20:21], v12 offset:4096
ds_read_b64_tr_b16 v[22:23], v12 offset:4608
s_add_u32 m0, s71, 0x6800
s_nop 0
buffer_load_dwordx4 v7, s[36:39], s64 offen offset:2048 lds
v_mfma_f32_32x32x16_bf16 v[132:147], a[84:87], v[40:43], v[132:147]
ds_read_b64_tr_b16 v[24:25], v12 offset:12288
ds_read_b64_tr_b16 v[26:27], v12 offset:12800
ds_read_b64_tr_b16 v[28:29], v12 offset:6144
buffer_load_dwordx4 v8, s[36:39], s64 offen offset:3072 lds
s_add_u32 s64, s64, 0x30000
v_mfma_f32_32x32x16_bf16 v[84:99], a[88:91], v[44:47], v[84:99]
ds_read_b64_tr_b16 v[30:31], v12 offset:6656
ds_read_b64_tr_b16 v[32:33], v12 offset:14336
ds_read_b64_tr_b16 v[34:35], v12 offset:14848
s_cmp_eq_u32 s64, 0x180000
s_cselect_b32 s64, 0, s64
v_mfma_f32_32x32x16_bf16 v[100:115], a[92:95], v[44:47], v[100:115]
s_add_u32 m0, s72, 0x8000
s_nop 0
buffer_load_dwordx4 v2, s[32:35], s65 offen lds
buffer_load_dwordx4 v3, s[32:35], s65 offen offset:1024 lds
buffer_load_dwordx4 v4, s[32:35], s65 offen offset:2048 lds
v_mfma_f32_32x32x16_bf16 v[116:131], a[88:91], v[48:51], v[116:131]
buffer_load_dwordx4 v5, s[32:35], s65 offen offset:3072 lds
s_add_u32 s65, s65, 128
v_mfma_f32_32x32x16_bf16 v[132:147], a[92:95], v[48:51], v[132:147]
s_and_b32 s65, s65, 1023
s_waitcnt lgkmcnt(0)
v_mfma_f32_32x32x16_bf16 v[84:99], a[96:99], v[20:23], v[84:99]
ds_read_b64_tr_b16 v[36:37], v12 offset:8192
ds_read_b64_tr_b16 v[38:39], v12 offset:8704
s_add_u32 m0, s71, 0x8c00
v_mfma_f32_32x32x16_bf16 v[100:115], a[100:103], v[20:23], v[100:115]
ds_read_b64_tr_b16 v[40:41], v12 offset:16384
ds_read_b64_tr_b16 v[42:43], v12 offset:16896
buffer_load_dwordx4 v7, s[36:39], s64 offen offset:1024 lds
v_mfma_f32_32x32x16_bf16 v[116:131], a[96:99], v[24:27], v[116:131]
ds_read_b64_tr_b16 v[44:45], v12 offset:10240
buffer_load_dwordx4 v8, s[36:39], s64 offen offset:2048 lds
v_mfma_f32_32x32x16_bf16 v[132:147], a[100:103], v[24:27], v[132:147]
ds_read_b64_tr_b16 v[46:47], v12 offset:10752
ds_read_b64_tr_b16 v[48:49], v12 offset:18432
s_add_u32 m0, s71, 0xa800
v_mfma_f32_32x32x16_bf16 v[84:99], a[104:107], v[28:31], v[84:99]
ds_read_b64_tr_b16 v[50:51], v12 offset:18944
buffer_load_dwordx4 v7, s[36:39], s64 offen offset:2048 lds
v_mfma_f32_32x32x16_bf16 v[100:115], a[108:111], v[28:31], v[100:115]
buffer_load_dwordx4 v8, s[36:39], s64 offen offset:3072 lds
v_mfma_f32_32x32x16_bf16 v[116:131], a[104:107], v[32:35], v[116:131]
s_add_u32 s64, s64, 0x30000
v_mfma_f32_32x32x16_bf16 v[132:147], a[108:111], v[32:35], v[132:147]
s_cmp_eq_u32 s64, 0x180000
s_cselect_b32 s64, 0, s64
s_waitcnt lgkmcnt(0)
s_waitcnt vmcnt(20)
s_barrier
v_mfma_f32_32x32x16_bf16 v[84:99], a[112:115], v[36:39], v[84:99]
ds_read_b128 a[128:131], v72 offset:0
ds_read_b128 a[132:135], v72 offset:4096
ds_read_b128 a[136:139], v73 offset:0
ds_read_b128 a[140:143], v73 offset:4096
s_add_u32 m0, s72, 0xc000
v_mfma_f32_32x32x16_bf16 v[100:115], a[116:119], v[36:39], v[100:115]
ds_read_b128 a[144:147], v74 offset:0
ds_read_b128 a[148:151], v74 offset:4096
ds_read_b128 a[152:155], v75 offset:0
buffer_load_dwordx4 v2, s[32:35], s65 offen lds
buffer_load_dwordx4 v3, s[32:35], s65 offen offset:1024 lds
v_mfma_f32_32x32x16_bf16 v[116:131], a[112:115], v[40:43], v[116:131]
ds_read_b128 a[156:159], v75 offset:4096
ds_read_b64_tr_b16 v[20:21], v12 offset:20480
ds_read_b64_tr_b16 v[22:23], v12 offset:20992
buffer_load_dwordx4 v4, s[32:35], s65 offen offset:2048 lds
buffer_load_dwordx4 v5, s[32:35], s65 offen offset:3072 lds
v_mfma_f32_32x32x16_bf16 v[132:147], a[116:119], v[40:43], v[132:147]
ds_read_b64_tr_b16 v[24:25], v12 offset:28672
ds_read_b64_tr_b16 v[26:27], v12 offset:29184
ds_read_b64_tr_b16 v[28:29], v12 offset:22528
s_add_u32 s65, s65, 128
s_and_b32 s65, s65, 1023
v_mfma_f32_32x32x16_bf16 v[84:99], a[120:123], v[44:47], v[84:99]
ds_read_b64_tr_b16 v[30:31], v12 offset:23040
ds_read_b64_tr_b16 v[32:33], v12 offset:30720
ds_read_b64_tr_b16 v[34:35], v12 offset:31232
s_add_u32 m0, s71, 0xd000
s_nop 0
buffer_load_dwordx4 v7, s[36:39], s64 offen offset:0 lds
v_mfma_f32_32x32x16_bf16 v[100:115], a[124:127], v[44:47], v[100:115]
buffer_load_dwordx4 v8, s[36:39], s64 offen offset:1024 lds
s_add_u32 s64, s64, 0x30000
s_cmp_eq_u32 s64, 0x180000
s_cselect_b32 s64, 0, s64
s_add_u32 m0, s71, 0xf000
v_mfma_f32_32x32x16_bf16 v[116:131], a[120:123], v[48:51], v[116:131]
buffer_load_dwordx4 v7, s[36:39], s64 offen offset:0 lds
buffer_load_dwordx4 v8, s[36:39], s64 offen offset:1024 lds
v_mfma_f32_32x32x16_bf16 v[132:147], a[124:127], v[48:51], v[132:147]
s_add_u32 s64, s64, 0x30000
s_cmp_eq_u32 s64, 0x180000
s_cselect_b32 s64, 0, s64
s_waitcnt lgkmcnt(0)
v_mfma_f32_32x32x16_bf16 v[84:99], a[128:131], v[20:23], v[84:99]
ds_read_b64_tr_b16 v[36:37], v12 offset:24576
ds_read_b64_tr_b16 v[38:39], v12 offset:25088
v_mfma_f32_32x32x16_bf16 v[100:115], a[132:135], v[20:23], v[100:115]
ds_read_b64_tr_b16 v[40:41], v12 offset:32768
ds_read_b64_tr_b16 v[42:43], v12 offset:33280
v_mfma_f32_32x32x16_bf16 v[116:131], a[128:131], v[24:27], v[116:131]
ds_read_b64_tr_b16 v[44:45], v12 offset:26624
v_mfma_f32_32x32x16_bf16 v[132:147], a[132:135], v[24:27], v[132:147]
ds_read_b64_tr_b16 v[46:47], v12 offset:27136
ds_read_b64_tr_b16 v[48:49], v12 offset:34816
v_mfma_f32_32x32x16_bf16 v[84:99], a[136:139], v[28:31], v[84:99]
ds_read_b64_tr_b16 v[50:51], v12 offset:35328
v_mfma_f32_32x32x16_bf16 v[100:115], a[140:143], v[28:31], v[100:115]
v_mfma_f32_32x32x16_bf16 v[116:131], a[136:139], v[32:35], v[116:131]
v_mfma_f32_32x32x16_bf16 v[132:147], a[140:143], v[32:35], v[132:147]
s_waitcnt lgkmcnt(0)
s_waitcnt vmcnt(20)
s_barrier
v_mfma_f32_32x32x16_bf16 v[84:99], a[144:147], v[36:39], v[84:99]
ds_read_b128 a[160:163], v72 offset:16384
ds_read_b128 a[164:167], v72 offset:20480
ds_read_b128 a[168:171], v73 offset:16384
ds_read_b128 a[172:175], v73 offset:20480
s_add_u32 m0, s71, 0x11000
v_mfma_f32_32x32x16_bf16 v[100:115], a[148:151], v[36:39], v[100:115]
ds_read_b128 a[176:179], v74 offset:16384
ds_read_b128 a[180:183], v74 offset:20480
ds_read_b128 a[184:187], v75 offset:16384
buffer_load_dwordx4 v7, s[36:39], s64 offen offset:0 lds
buffer_load_dwordx4 v8, s[36:39], s64 offen offset:1024 lds
v_mfma_f32_32x32x16_bf16 v[116:131], a[144:147], v[40:43], v[116:131]
ds_read_b128 a[188:191], v75 offset:20480
ds_read_b64_tr_b16 v[20:21], v10 offset:4096
ds_read_b64_tr_b16 v[22:23], v10 offset:4608
s_add_u32 s64, s64, 0x30000
v_mfma_f32_32x32x16_bf16 v[132:147], a[148:151], v[40:43], v[132:147]
ds_read_b64_tr_b16 v[24:25], v10 offset:12288
ds_read_b64_tr_b16 v[26:27], v10 offset:12800
ds_read_b64_tr_b16 v[28:29], v10 offset:6144
s_cmp_eq_u32 s64, 0x180000
s_cselect_b32 s64, 0, s64
v_mfma_f32_32x32x16_bf16 v[84:99], a[152:155], v[44:47], v[84:99]
ds_read_b64_tr_b16 v[30:31], v10 offset:6656
ds_read_b64_tr_b16 v[32:33], v10 offset:14336
ds_read_b64_tr_b16 v[34:35], v10 offset:14848
s_add_u32 m0, s71, 0x13000
s_nop 0
buffer_load_dwordx4 v7, s[36:39], s64 offen offset:0 lds
v_mfma_f32_32x32x16_bf16 v[100:115], a[156:159], v[44:47], v[100:115]
buffer_load_dwordx4 v8, s[36:39], s64 offen offset:1024 lds
v_mfma_f32_32x32x16_bf16 v[116:131], a[152:155], v[48:51], v[116:131]
s_add_u32 s64, s64, 0x30000
v_mfma_f32_32x32x16_bf16 v[132:147], a[156:159], v[48:51], v[132:147]
s_cmp_eq_u32 s64, 0x180000
s_cselect_b32 s64, 0, s64
s_waitcnt lgkmcnt(0)
v_mfma_f32_32x32x16_bf16 v[84:99], a[160:163], v[20:23], v[84:99]
ds_read_b64_tr_b16 v[36:37], v10 offset:8192
ds_read_b64_tr_b16 v[38:39], v10 offset:8704
v_mov_b32 v244, 0
v_mfma_f32_32x32x16_bf16 v[100:115], a[164:167], v[20:23], v[100:115]
ds_read_b64_tr_b16 v[40:41], v10 offset:16384
ds_read_b64_tr_b16 v[42:43], v10 offset:16896
v_mfma_f32_32x32x16_bf16 v[116:131], a[160:163], v[24:27], v[116:131]
ds_read_b64_tr_b16 v[44:45], v10 offset:10240
v_mfma_f32_32x32x16_bf16 v[132:147], a[164:167], v[24:27], v[132:147]
ds_read_b64_tr_b16 v[46:47], v10 offset:10752
ds_read_b64_tr_b16 v[48:49], v10 offset:18432
v_mfma_f32_32x32x16_bf16 v[84:99], a[168:171], v[28:31], v[84:99]
ds_read_b64_tr_b16 v[50:51], v10 offset:18944
global_load_dword v245, v244, s[22:23] sc1
v_mfma_f32_32x32x16_bf16 v[100:115], a[172:175], v[28:31], v[100:115]
v_mfma_f32_32x32x16_bf16 v[116:131], a[168:171], v[32:35], v[116:131]
v_mfma_f32_32x32x16_bf16 v[132:147], a[172:175], v[32:35], v[132:147]
s_waitcnt lgkmcnt(0)
s_waitcnt vmcnt(17)
s_barrier
v_mfma_f32_32x32x16_bf16 v[84:99], a[176:179], v[36:39], v[84:99]
ds_read_b128 a[192:195], v72 offset:32768
ds_read_b128 a[196:199], v72 offset:36864
ds_read_b128 a[200:203], v73 offset:32768
ds_read_b128 a[204:207], v73 offset:36864
s_add_u32 m0, s71, 0x1000
v_mfma_f32_32x32x16_bf16 v[100:115], a[180:183], v[36:39], v[100:115]
ds_read_b128 a[208:211], v74 offset:32768
ds_read_b128 a[212:215], v74 offset:36864
ds_read_b128 a[216:219], v75 offset:32768
buffer_load_dwordx4 v7, s[36:39], s64 offen offset:0 lds
buffer_load_dwordx4 v8, s[36:39], s64 offen offset:1024 lds
v_mfma_f32_32x32x16_bf16 v[116:131], a[176:179], v[40:43], v[116:131]
ds_read_b128 a[220:223], v75 offset:36864
ds_read_b64_tr_b16 v[20:21], v10 offset:20480
ds_read_b64_tr_b16 v[22:23], v10 offset:20992
s_add_u32 s64, s64, 0x30000
v_mfma_f32_32x32x16_bf16 v[132:147], a[180:183], v[40:43], v[132:147]
ds_read_b64_tr_b16 v[24:25], v10 offset:28672
ds_read_b64_tr_b16 v[26:27], v10 offset:29184
ds_read_b64_tr_b16 v[28:29], v10 offset:22528
s_cmp_eq_u32 s64, 0x180000
s_cselect_b32 s64, 0, s64
v_mfma_f32_32x32x16_bf16 v[84:99], a[184:187], v[44:47], v[84:99]
ds_read_b64_tr_b16 v[30:31], v10 offset:23040
ds_read_b64_tr_b16 v[32:33], v10 offset:30720
ds_read_b64_tr_b16 v[34:35], v10 offset:31232
s_add_u32 m0, s71, 0x3000
s_nop 0
buffer_load_dwordx4 v7, s[36:39], s64 offen offset:0 lds
v_mfma_f32_32x32x16_bf16 v[100:115], a[188:191], v[44:47], v[100:115]
buffer_load_dwordx4 v8, s[36:39], s64 offen offset:1024 lds
v_mfma_f32_32x32x16_bf16 v[116:131], a[184:187], v[48:51], v[116:131]
s_add_u32 s64, s64, 0x30000
v_mfma_f32_32x32x16_bf16 v[132:147], a[188:191], v[48:51], v[132:147]
s_cmp_eq_u32 s64, 0x180000
s_cselect_b32 s64, 0, s64
s_waitcnt lgkmcnt(0)
v_mfma_f32_32x32x16_bf16 v[84:99], a[192:195], v[20:23], v[84:99]
ds_read_b64_tr_b16 v[36:37], v10 offset:24576
ds_read_b64_tr_b16 v[38:39], v10 offset:25088
v_mfma_f32_32x32x16_bf16 v[100:115], a[196:199], v[20:23], v[100:115]
ds_read_b64_tr_b16 v[40:41], v10 offset:32768
ds_read_b64_tr_b16 v[42:43], v10 offset:33280
v_mfma_f32_32x32x16_bf16 v[116:131], a[192:195], v[24:27], v[116:131]
ds_read_b64_tr_b16 v[44:45], v10 offset:26624
v_mfma_f32_32x32x16_bf16 v[132:147], a[196:199], v[24:27], v[132:147]
ds_read_b64_tr_b16 v[46:47], v10 offset:27136
ds_read_b64_tr_b16 v[48:49], v10 offset:34816
v_mfma_f32_32x32x16_bf16 v[84:99], a[200:203], v[28:31], v[84:99]
ds_read_b64_tr_b16 v[50:51], v10 offset:35328
v_mfma_f32_32x32x16_bf16 v[100:115], a[204:207], v[28:31], v[100:115]
v_mfma_f32_32x32x16_bf16 v[116:131], a[200:203], v[32:35], v[116:131]
v_mfma_f32_32x32x16_bf16 v[132:147], a[204:207], v[32:35], v[132:147]
s_waitcnt lgkmcnt(0)
s_waitcnt vmcnt(13)
s_barrier
v_mfma_f32_32x32x16_bf16 v[84:99], a[208:211], v[36:39], v[84:99]
ds_read_b128 a[224:227], v72 offset:49152
ds_read_b128 a[228:231], v72 offset:53248
ds_read_b128 a[232:235], v73 offset:49152
ds_read_b128 a[236:239], v73 offset:53248
s_add_u32 m0, s71, 0x5000
v_mfma_f32_32x32x16_bf16 v[100:115], a[212:215], v[36:39], v[100:115]
ds_read_b128 a[240:243], v74 offset:49152
ds_read_b128 a[244:247], v74 offset:53248
ds_read_b128 a[248:251], v75 offset:49152
buffer_load_dwordx4 v7, s[36:39], s64 offen offset:0 lds
buffer_load_dwordx4 v8, s[36:39], s64 offen offset:1024 lds
v_mfma_f32_32x32x16_bf16 v[116:131], a[208:211], v[40:43], v[116:131]
ds_read_b128 a[252:255], v75 offset:53248
ds_read_b64_tr_b16 v[20:21], v10 offset:36864
ds_read_b64_tr_b16 v[22:23], v10 offset:37376
s_add_u32 s64, s64, 0x30000
v_mfma_f32_32x32x16_bf16 v[132:147], a[212:215], v[40:43], v[132:147]
ds_read_b64_tr_b16 v[24:25], v10 offset:45056
ds_read_b64_tr_b16 v[26:27], v10 offset:45568
ds_read_b64_tr_b16 v[28:29], v10 offset:38912
s_cmp_eq_u32 s64, 0x180000
s_cselect_b32 s64, 0, s64
v_mfma_f32_32x32x16_bf16 v[84:99], a[216:219], v[44:47], v[84:99]
ds_read_b64_tr_b16 v[30:31], v10 offset:39424
ds_read_b64_tr_b16 v[32:33], v10 offset:47104
ds_read_b64_tr_b16 v[34:35], v10 offset:47616
s_add_u32 m0, s71, 0x7000
s_nop 0
buffer_load_dwordx4 v7, s[36:39], s64 offen offset:0 lds
v_mfma_f32_32x32x16_bf16 v[100:115], a[220:223], v[44:47], v[100:115]
buffer_load_dwordx4 v8, s[36:39], s64 offen offset:1024 lds
s_add_u32 s64, s64, 0x30000
s_cmp_eq_u32 s64, 0x180000
s_cselect_b32 s64, 0, s64
s_lshr_b32 s58, s2, 6
v_mfma_f32_32x32x16_bf16 v[116:131], a[216:219], v[48:51], v[116:131]
s_lshl_b32 s58, s58, 2
s_add_u32 s58, s58, s29
s_lshl_b32 s58, s58, 15
s_lshl_b32 s59, s31, 7
s_add_u32 s58, s58, s59
v_mfma_f32_32x32x16_bf16 v[132:147], a[220:223], v[48:51], v[132:147]
v_lshlrev_b32 v81, 10, v1
s_mov_b64 exec, 0xffffffff
buffer_load_dword v82, v81, s[40:43], s58 offen
s_mov_b64 exec, -1
s_waitcnt lgkmcnt(0)
v_mfma_f32_32x32x16_bf16 v[84:99], a[224:227], v[20:23], v[84:99]
ds_read_b64_tr_b16 v[36:37], v10 offset:40960
ds_read_b64_tr_b16 v[38:39], v10 offset:41472
s_mov_b32 s54, 0x3fb8aa3b
s_mov_b32 s55, 0x3fb8aa3b
s_mov_b32 s58, 0x358637bd
v_mfma_f32_32x32x16_bf16 v[100:115], a[228:231], v[20:23], v[100:115]
ds_read_b64_tr_b16 v[40:41], v10 offset:49152
ds_read_b64_tr_b16 v[42:43], v10 offset:49664
v_mov_b32 v220, 0xb5c1a2a0
v_mov_b32 v221, 0xb5c1a2a0
v_mov_b32 v224, 0x3f803f80
v_mfma_f32_32x32x16_bf16 v[116:131], a[224:227], v[24:27], v[116:131]
ds_read_b64_tr_b16 v[44:45], v10 offset:43008
v_mov_b32 v225, 0x3f803f80
v_mov_b32 v226, 0x3f803f80
v_mov_b32 v227, 0x3f803f80
v_lshlrev_b32 v222, 4, v1
v_mfma_f32_32x32x16_bf16 v[132:147], a[228:231], v[24:27], v[132:147]
ds_read_b64_tr_b16 v[46:47], v10 offset:43520
ds_read_b64_tr_b16 v[48:49], v10 offset:51200
s_lshl_b32 s53, s29, 11
s_add_u32 s53, s53, 86016
v_add_u32 v236, s53, v222
v_mfma_f32_32x32x16_bf16 v[84:99], a[232:235], v[28:31], v[84:99]
ds_read_b64_tr_b16 v[50:51], v10 offset:51712
v_lshlrev_b32 v223, 2, v1
s_lshl_b32 s53, s29, 8
s_add_u32 s53, s53, 94208
v_mfma_f32_32x32x16_bf16 v[100:115], a[236:239], v[28:31], v[100:115]
v_add_u32 v237, s53, v223
s_and_b32 s52, s29, 1
s_lshl_b32 s53, s52, 11
v_mfma_f32_32x32x16_bf16 v[116:131], a[232:235], v[32:35], v[116:131]
s_lshr_b32 s66, s29, 1
s_lshl_b32 s67, s66, 10
s_add_u32 s53, s53, s67
v_mfma_f32_32x32x16_bf16 v[132:147], a[236:239], v[32:35], v[132:147]
s_waitcnt lgkmcnt(0)
s_waitcnt vmcnt(14)
s_barrier
v_mfma_f32_32x32x16_bf16 v[84:99], a[240:243], v[36:39], v[84:99]
ds_read_b64_tr_b16 v[20:21], v12 offset:4096
ds_read_b64_tr_b16 v[22:23], v12 offset:4608
s_add_u32 s53, s53, 86016
v_add_u32 v238, s53, v222
s_lshl_b32 s53, s52, 8
v_mfma_f32_32x32x16_bf16 v[100:115], a[244:247], v[36:39], v[100:115]
ds_read_b64_tr_b16 v[24:25], v12 offset:6144
ds_read_b64_tr_b16 v[26:27], v12 offset:6656
s_add_u32 s53, s53, 94208
v_add_u32 v239, s53, v223
v_and_b32 v241, 15, v1
v_mfma_f32_32x32x16_bf16 v[116:131], a[240:243], v[40:43], v[116:131]
ds_read_b64_tr_b16 v[28:29], v12 offset:8192
v_lshlrev_b32 v241, 2, v241
v_bfe_u32 v222, v1, 4, 1
v_mul_u32_u24 v222, 1280, v222
v_mfma_f32_32x32x16_bf16 v[132:147], a[244:247], v[40:43], v[132:147]
ds_read_b64_tr_b16 v[30:31], v12 offset:8704
ds_read_b64_tr_b16 v[32:33], v12 offset:10240
v_add_u32 v241, v241, v222
v_lshrrev_b32 v222, 5, v1
v_lshl_add_u32 v240, v222, 8, v241
v_mfma_f32_32x32x16_bf16 v[84:99], a[248:251], v[44:47], v[84:99]
ds_read_b64_tr_b16 v[34:35], v12 offset:10752
s_lshl_b32 s52, s52, 1
s_lshl_b32 s53, s28, 2
s_add_u32 s52, s52, s53
v_mfma_f32_32x32x16_bf16 v[100:115], a[252:255], v[44:47], v[100:115]
s_mul_i32 s52, s52, 1280
s_add_u32 s61, s52, 0x4000
s_lshl_b32 s53, s66, 9
v_mfma_f32_32x32x16_bf16 v[116:131], a[248:251], v[48:51], v[116:131]
s_add_u32 s60, s53, s61
s_lshl_b32 s66, s66, 4
s_lshl_b32 s66, 0xffff, s66
v_mfma_f32_32x32x16_bf16 v[132:147], a[252:255], v[48:51], v[132:147]
s_waitcnt lgkmcnt(0)
v_pk_fma_f32 v[216:217], v[84:85], s[54:55], v[220:221]
v_pk_fma_f32 v[218:219], v[86:87], s[54:55], v[220:221]
v_exp_f32_e64 v216, v216 clamp
v_exp_f32_e64 v217, v217 clamp
v_exp_f32_e64 v218, v218 clamp
v_exp_f32_e64 v219, v219 clamp
v_max_f32 v84, s58, v84
v_max_f32 v85, s58, v85
v_max_f32 v86, s58, v86
v_max_f32 v87, s58, v87
v_pk_add_f32 v[84:85], v[84:85], v[216:217]
v_pk_add_f32 v[86:87], v[86:87], v[218:219]
v_cvt_pk_bf16_f32 v184, v84, v85
v_cvt_pk_bf16_f32 v185, v86, v87
v_cvt_pk_bf16_f32 v200, v116, v117
v_cvt_pk_bf16_f32 v201, v118, v119
v_pk_fma_f32 v[228:229], v[88:89], s[54:55], v[220:221]
v_pk_fma_f32 v[230:231], v[90:91], s[54:55], v[220:221]
v_exp_f32_e64 v228, v228 clamp
v_exp_f32_e64 v229, v229 clamp
v_exp_f32_e64 v230, v230 clamp
v_exp_f32_e64 v231, v231 clamp
v_max_f32 v88, s58, v88
v_max_f32 v89, s58, v89
v_max_f32 v90, s58, v90
v_max_f32 v91, s58, v91
v_pk_add_f32 v[88:89], v[88:89], v[228:229]
v_pk_add_f32 v[90:91], v[90:91], v[230:231]
v_cvt_pk_bf16_f32 v186, v88, v89
v_cvt_pk_bf16_f32 v187, v90, v91
v_cvt_pk_bf16_f32 v202, v120, v121
v_cvt_pk_bf16_f32 v203, v122, v123
v_pk_fma_f32 v[216:217], v[92:93], s[54:55], v[220:221]
v_pk_fma_f32 v[218:219], v[94:95], s[54:55], v[220:221]
v_exp_f32_e64 v216, v216 clamp
v_exp_f32_e64 v217, v217 clamp
v_exp_f32_e64 v218, v218 clamp
v_exp_f32_e64 v219, v219 clamp
v_max_f32 v92, s58, v92
v_max_f32 v93, s58, v93
v_max_f32 v94, s58, v94
v_max_f32 v95, s58, v95
v_pk_add_f32 v[92:93], v[92:93], v[216:217]
v_pk_add_f32 v[94:95], v[94:95], v[218:219]
v_cvt_pk_bf16_f32 v188, v92, v93
v_cvt_pk_bf16_f32 v189, v94, v95
v_cvt_pk_bf16_f32 v204, v124, v125
v_cvt_pk_bf16_f32 v205, v126, v127
v_pk_fma_f32 v[228:229], v[96:97], s[54:55], v[220:221]
v_pk_fma_f32 v[230:231], v[98:99], s[54:55], v[220:221]
v_exp_f32_e64 v228, v228 clamp
v_exp_f32_e64 v229, v229 clamp
v_exp_f32_e64 v230, v230 clamp
v_exp_f32_e64 v231, v231 clamp
v_max_f32 v96, s58, v96
v_max_f32 v97, s58, v97
v_max_f32 v98, s58, v98
v_max_f32 v99, s58, v99
v_pk_add_f32 v[96:97], v[96:97], v[228:229]
v_pk_add_f32 v[98:99], v[98:99], v[230:231]
v_cvt_pk_bf16_f32 v190, v96, v97
v_cvt_pk_bf16_f32 v191, v98, v99
v_cvt_pk_bf16_f32 v206, v128, v129
v_cvt_pk_bf16_f32 v207, v130, v131
v_mfma_f32_32x32x16_bf16 v[116:131], v[200:203], v[184:187], 0
v_mfma_f32_32x32x16_bf16 v[84:99], v[224:227], v[184:187], 0
v_mfma_f32_32x32x16_bf16 v[116:131], v[204:207], v[188:191], v[116:131]
v_mfma_f32_32x32x16_bf16 v[84:99], v[224:227], v[188:191], v[84:99]
v_pk_fma_f32 v[216:217], v[100:101], s[54:55], v[220:221]
v_pk_fma_f32 v[218:219], v[102:103], s[54:55], v[220:221]
v_exp_f32_e64 v216, v216 clamp
v_exp_f32_e64 v217, v217 clamp
v_exp_f32_e64 v218, v218 clamp
v_exp_f32_e64 v219, v219 clamp
v_max_f32 v100, s58, v100
v_max_f32 v101, s58, v101
v_max_f32 v102, s58, v102
v_max_f32 v103, s58, v103
v_pk_add_f32 v[100:101], v[100:101], v[216:217]
v_pk_add_f32 v[102:103], v[102:103], v[218:219]
v_cvt_pk_bf16_f32 v192, v100, v101
v_cvt_pk_bf16_f32 v193, v102, v103
v_cvt_pk_bf16_f32 v208, v132, v133
v_cvt_pk_bf16_f32 v209, v134, v135
v_pk_fma_f32 v[228:229], v[104:105], s[54:55], v[220:221]
v_pk_fma_f32 v[230:231], v[106:107], s[54:55], v[220:221]
v_exp_f32_e64 v228, v228 clamp
v_exp_f32_e64 v229, v229 clamp
v_exp_f32_e64 v230, v230 clamp
v_exp_f32_e64 v231, v231 clamp
v_max_f32 v104, s58, v104
v_max_f32 v105, s58, v105
v_max_f32 v106, s58, v106
v_max_f32 v107, s58, v107
v_pk_add_f32 v[104:105], v[104:105], v[228:229]
v_pk_add_f32 v[106:107], v[106:107], v[230:231]
v_cvt_pk_bf16_f32 v194, v104, v105
v_cvt_pk_bf16_f32 v195, v106, v107
v_cvt_pk_bf16_f32 v210, v136, v137
v_cvt_pk_bf16_f32 v211, v138, v139
v_pk_fma_f32 v[216:217], v[108:109], s[54:55], v[220:221]
v_pk_fma_f32 v[218:219], v[110:111], s[54:55], v[220:221]
v_exp_f32_e64 v216, v216 clamp
v_exp_f32_e64 v217, v217 clamp
v_exp_f32_e64 v218, v218 clamp
v_exp_f32_e64 v219, v219 clamp
v_max_f32 v108, s58, v108
v_max_f32 v109, s58, v109
v_max_f32 v110, s58, v110
v_max_f32 v111, s58, v111
v_pk_add_f32 v[108:109], v[108:109], v[216:217]
v_pk_add_f32 v[110:111], v[110:111], v[218:219]
v_cvt_pk_bf16_f32 v196, v108, v109
v_cvt_pk_bf16_f32 v197, v110, v111
v_cvt_pk_bf16_f32 v212, v140, v141
v_cvt_pk_bf16_f32 v213, v142, v143
v_pk_fma_f32 v[228:229], v[112:113], s[54:55], v[220:221]
v_pk_fma_f32 v[230:231], v[114:115], s[54:55], v[220:221]
v_exp_f32_e64 v228, v228 clamp
v_exp_f32_e64 v229, v229 clamp
v_exp_f32_e64 v230, v230 clamp
v_exp_f32_e64 v231, v231 clamp
v_max_f32 v112, s58, v112
v_max_f32 v113, s58, v113
v_max_f32 v114, s58, v114
v_max_f32 v115, s58, v115
v_pk_add_f32 v[112:113], v[112:113], v[228:229]
v_pk_add_f32 v[114:115], v[114:115], v[230:231]
v_cvt_pk_bf16_f32 v198, v112, v113
v_cvt_pk_bf16_f32 v199, v114, v115
v_cvt_pk_bf16_f32 v214, v144, v145
v_cvt_pk_bf16_f32 v215, v146, v147
v_mfma_f32_32x32x16_bf16 v[116:131], v[208:211], v[192:195], v[116:131]
v_mfma_f32_32x32x16_bf16 v[84:99], v[224:227], v[192:195], v[84:99]
v_mfma_f32_32x32x16_bf16 v[116:131], v[212:215], v[196:199], v[116:131]
v_mfma_f32_32x32x16_bf16 v[84:99], v[224:227], v[196:199], v[84:99]
s_mov_b32 s52, 0x0000ffff
s_mov_b32 s53, s52
s_mov_b64 exec, s[52:53]
s_nop 7
ds_write_b128 v236, v[116:119]
ds_write_b128 v236, v[120:123] offset:1024
s_not_b64 exec, exec
ds_write_b128 v236, v[124:127]
ds_write_b128 v236, v[128:131] offset:1024
s_mov_b64 exec, -1
ds_write_b32 v237, v84
s_waitcnt vmcnt(9)
v_readfirstlane_b32 s57, v245
s_nop 3
s_cmp_ge_u32 s57, 16
s_cbranch_scc1 L_ok_initA
s_mov_b32 s56, 0
L_spin_initA:
global_load_dword v245, v244, s[22:23] sc1
s_waitcnt vmcnt(0)
v_readfirstlane_b32 s57, v245
s_add_u32 s56, s56, 1
s_cmp_ge_u32 s56, 0xf4240
s_cbranch_scc1 L_spun_initA
s_nop 0
s_cmp_lt_u32 s57, 16
s_cbranch_scc1 L_spin_initA
L_spun_initA:
L_ok_initA:
s_waitcnt lgkmcnt(0)
s_barrier
ds_read_b128 v[228:231], v238 offset:0
ds_read_b32 v246, v239 offset:0
ds_read_b128 v[232:235], v238 offset:4096
ds_read_b32 v247, v239 offset:512
s_waitcnt lgkmcnt(0)
v_add_f32 v228, v228, v232
v_add_f32 v229, v229, v233
v_add_f32 v230, v230, v234
v_add_f32 v231, v231, v235
v_add_f32 v246, v246, v247
buffer_atomic_add_f32 v228, v240, s[44:47], s60 offen offset:0
buffer_atomic_add_f32 v229, v240, s[44:47], s60 offen offset:64
buffer_atomic_add_f32 v230, v240, s[44:47], s60 offen offset:128
buffer_atomic_add_f32 v231, v240, s[44:47], s60 offen offset:192
s_mov_b32 exec_lo, s66
s_mov_b32 exec_hi, 0
buffer_atomic_add_f32 v246, v241, s[44:47], s61 offen offset:1024
s_mov_b64 exec, -1
v_mfma_f32_32x32x16_bf16 v[148:163], v[20:23], a[0:3], v[56:71]
ds_read_b64_tr_b16 v[36:37], v12 offset:12288
ds_read_b64_tr_b16 v[38:39], v12 offset:12800
v_mfma_f32_32x32x16_bf16 v[164:179], v[20:23], a[4:7], v[56:71]
ds_read_b64_tr_b16 v[40:41], v12 offset:14336
ds_read_b64_tr_b16 v[42:43], v12 offset:14848
v_mfma_f32_32x32x16_bf16 v[148:163], v[24:27], a[8:11], v[148:163]
ds_read_b64_tr_b16 v[44:45], v12 offset:16384
v_mfma_f32_32x32x16_bf16 v[164:179], v[24:27], a[12:15], v[164:179]
ds_read_b64_tr_b16 v[46:47], v12 offset:16896
ds_read_b64_tr_b16 v[48:49], v12 offset:18432
v_mfma_f32_32x32x16_bf16 v[148:163], v[28:31], a[16:19], v[148:163]
ds_read_b64_tr_b16 v[50:51], v12 offset:18944
v_mfma_f32_32x32x16_bf16 v[164:179], v[28:31], a[20:23], v[164:179]
v_mfma_f32_32x32x16_bf16 v[148:163], v[32:35], a[24:27], v[148:163]
v_mfma_f32_32x32x16_bf16 v[164:179], v[32:35], a[28:31], v[164:179]
s_waitcnt lgkmcnt(0)
s_barrier
v_mfma_f32_32x32x16_bf16 v[148:163], v[36:39], a[32:35], v[148:163]
ds_read_b64_tr_b16 v[20:21], v12 offset:20480
ds_read_b64_tr_b16 v[22:23], v12 offset:20992
s_add_u32 m0, s70, 0x0
v_mfma_f32_32x32x16_bf16 v[164:179], v[36:39], a[36:39], v[164:179]
ds_read_b64_tr_b16 v[24:25], v12 offset:22528
ds_read_b64_tr_b16 v[26:27], v12 offset:23040
s_mov_b32 s59, 0x0
v_mfma_f32_32x32x16_bf16 v[148:163], v[40:43], a[40:43], v[148:163]
ds_read_b64_tr_b16 v[28:29], v12 offset:24576
buffer_load_dwordx4 v52, s[40:43], s59 offen lds
v_mfma_f32_32x32x16_bf16 v[164:179], v[40:43], a[44:47], v[164:179]
ds_read_b64_tr_b16 v[30:31], v12 offset:25088
ds_read_b64_tr_b16 v[32:33], v12 offset:26624
v_mfma_f32_32x32x16_bf16 v[148:163], v[44:47], a[48:51], v[148:163]
ds_read_b64_tr_b16 v[34:35], v12 offset:27136
buffer_load_dwordx4 v53, s[40:43], s59 offen offset:1024 lds
v_mfma_f32_32x32x16_bf16 v[164:179], v[44:47], a[52:55], v[164:179]
buffer_load_dwordx4 v54, s[40:43], s59 offen offset:2048 lds
v_mfma_f32_32x32x16_bf16 v[148:163], v[48:51], a[56:59], v[148:163]
buffer_load_dwordx4 v55, s[40:43], s59 offen offset:3072 lds
v_mfma_f32_32x32x16_bf16 v[164:179], v[48:51], a[60:63], v[164:179]
s_waitcnt lgkmcnt(0)
v_mfma_f32_32x32x16_bf16 v[148:163], v[20:23], a[64:67], v[148:163]
ds_read_b64_tr_b16 v[36:37], v12 offset:28672
ds_read_b64_tr_b16 v[38:39], v12 offset:29184
s_add_u32 m0, s70, 0x1000
v_mfma_f32_32x32x16_bf16 v[164:179], v[20:23], a[68:71], v[164:179]
ds_read_b64_tr_b16 v[40:41], v12 offset:30720
ds_read_b64_tr_b16 v[42:43], v12 offset:31232
s_mov_b32 s59, 0x8000
v_mfma_f32_32x32x16_bf16 v[148:163], v[24:27], a[72:75], v[148:163]
ds_read_b64_tr_b16 v[44:45], v12 offset:32768
buffer_load_dwordx4 v52, s[40:43], s59 offen lds
v_mfma_f32_32x32x16_bf16 v[164:179], v[24:27], a[76:79], v[164:179]
ds_read_b64_tr_b16 v[46:47], v12 offset:33280
ds_read_b64_tr_b16 v[48:49], v12 offset:34816
v_mfma_f32_32x32x16_bf16 v[148:163], v[28:31], a[80:83], v[148:163]
ds_read_b64_tr_b16 v[50:51], v12 offset:35328
buffer_load_dwordx4 v53, s[40:43], s59 offen offset:1024 lds
v_mfma_f32_32x32x16_bf16 v[164:179], v[28:31], a[84:87], v[164:179]
buffer_load_dwordx4 v54, s[40:43], s59 offen offset:2048 lds
v_mfma_f32_32x32x16_bf16 v[148:163], v[32:35], a[88:91], v[148:163]
buffer_load_dwordx4 v55, s[40:43], s59 offen offset:3072 lds
v_mfma_f32_32x32x16_bf16 v[164:179], v[32:35], a[92:95], v[164:179]
s_waitcnt lgkmcnt(0)
s_waitcnt vmcnt(18)
s_waitcnt vmcnt(8)
s_barrier
s_cmp_eq_u32 s29, 0
s_cbranch_scc0 L_A_nosig16
s_lshl_b32 s52, s28, 8
v_mov_b32 v180, s52
v_mov_b32 v181, 1
s_mov_b64 exec, 1
global_atomic_add v180, v181, s[24:25] sc1
s_mov_b64 exec, -1
L_A_nosig16:
v_mfma_f32_32x32x16_bf16 v[148:163], v[36:39], a[96:99], v[148:163]
ds_read_b64_tr_b16 v[20:21], v10 offset:4096
ds_read_b64_tr_b16 v[22:23], v10 offset:4608
s_add_u32 m0, s70, 0x2000
v_mfma_f32_32x32x16_bf16 v[164:179], v[36:39], a[100:103], v[164:179]
ds_read_b64_tr_b16 v[24:25], v10 offset:6144
ds_read_b64_tr_b16 v[26:27], v10 offset:6656
s_mov_b32 s59, 0x10000
v_mfma_f32_32x32x16_bf16 v[148:163], v[40:43], a[104:107], v[148:163]
ds_read_b64_tr_b16 v[28:29], v10 offset:8192
buffer_load_dwordx4 v52, s[40:43], s59 offen lds
v_mfma_f32_32x32x16_bf16 v[164:179], v[40:43], a[108:111], v[164:179]
ds_read_b64_tr_b16 v[30:31], v10 offset:8704
ds_read_b64_tr_b16 v[32:33], v10 offset:10240
v_mfma_f32_32x32x16_bf16 v[148:163], v[44:47], a[112:115], v[148:163]
ds_read_b64_tr_b16 v[34:35], v10 offset:10752
buffer_load_dwordx4 v53, s[40:43], s59 offen offset:1024 lds
v_mfma_f32_32x32x16_bf16 v[164:179], v[44:47], a[116:119], v[164:179]
buffer_load_dwordx4 v54, s[40:43], s59 offen offset:2048 lds
v_mfma_f32_32x32x16_bf16 v[148:163], v[48:51], a[120:123], v[148:163]
buffer_load_dwordx4 v55, s[40:43], s59 offen offset:3072 lds
v_mfma_f32_32x32x16_bf16 v[164:179], v[48:51], a[124:127], v[164:179]
s_waitcnt lgkmcnt(0)
v_mfma_f32_32x32x16_bf16 v[148:163], v[20:23], a[128:131], v[148:163]
ds_read_b64_tr_b16 v[36:37], v10 offset:12288
ds_read_b64_tr_b16 v[38:39], v10 offset:12800
s_add_u32 m0, s70, 0x3000
v_mfma_f32_32x32x16_bf16 v[164:179], v[20:23], a[132:135], v[164:179]
ds_read_b64_tr_b16 v[40:41], v10 offset:14336
ds_read_b64_tr_b16 v[42:43], v10 offset:14848
s_mov_b32 s59, 0x18000
v_mfma_f32_32x32x16_bf16 v[148:163], v[24:27], a[136:139], v[148:163]
ds_read_b64_tr_b16 v[44:45], v10 offset:16384
buffer_load_dwordx4 v52, s[40:43], s59 offen lds
v_mfma_f32_32x32x16_bf16 v[164:179], v[24:27], a[140:143], v[164:179]
ds_read_b64_tr_b16 v[46:47], v10 offset:16896
ds_read_b64_tr_b16 v[48:49], v10 offset:18432
v_mfma_f32_32x32x16_bf16 v[148:163], v[28:31], a[144:147], v[148:163]
ds_read_b64_tr_b16 v[50:51], v10 offset:18944
buffer_load_dwordx4 v53, s[40:43], s59 offen offset:1024 lds
v_mfma_f32_32x32x16_bf16 v[164:179], v[28:31], a[148:151], v[164:179]
buffer_load_dwordx4 v54, s[40:43], s59 offen offset:2048 lds
v_mfma_f32_32x32x16_bf16 v[148:163], v[32:35], a[152:155], v[148:163]
buffer_load_dwordx4 v55, s[40:43], s59 offen offset:3072 lds
v_mfma_f32_32x32x16_bf16 v[164:179], v[32:35], a[156:159], v[164:179]
s_waitcnt lgkmcnt(0)
s_barrier
v_mfma_f32_32x32x16_bf16 v[148:163], v[36:39], a[160:163], v[148:163]
ds_read_b64_tr_b16 v[20:21], v10 offset:20480
ds_read_b64_tr_b16 v[22:23], v10 offset:20992
v_mfma_f32_32x32x16_bf16 v[164:179], v[36:39], a[164:167], v[164:179]
ds_read_b64_tr_b16 v[24:25], v10 offset:22528
ds_read_b64_tr_b16 v[26:27], v10 offset:23040
v_mfma_f32_32x32x16_bf16 v[148:163], v[40:43], a[168:171], v[148:163]
ds_read_b64_tr_b16 v[28:29], v10 offset:24576
v_mfma_f32_32x32x16_bf16 v[164:179], v[40:43], a[172:175], v[164:179]
ds_read_b64_tr_b16 v[30:31], v10 offset:25088
ds_read_b64_tr_b16 v[32:33], v10 offset:26624
v_mfma_f32_32x32x16_bf16 v[148:163], v[44:47], a[176:179], v[148:163]
ds_read_b64_tr_b16 v[34:35], v10 offset:27136
v_mfma_f32_32x32x16_bf16 v[164:179], v[44:47], a[180:183], v[164:179]
v_mfma_f32_32x32x16_bf16 v[148:163], v[48:51], a[184:187], v[148:163]
v_mfma_f32_32x32x16_bf16 v[164:179], v[48:51], a[188:191], v[164:179]
s_waitcnt lgkmcnt(0)
v_mfma_f32_32x32x16_bf16 v[148:163], v[20:23], a[192:195], v[148:163]
ds_read_b64_tr_b16 v[36:37], v10 offset:28672
ds_read_b64_tr_b16 v[38:39], v10 offset:29184
v_and_b32 v222, 3, v1
v_bfe_u32 v223, v1, 3, 1
v_mfma_f32_32x32x16_bf16 v[164:179], v[20:23], a[196:199], v[164:179]
ds_read_b64_tr_b16 v[40:41], v10 offset:30720
ds_read_b64_tr_b16 v[42:43], v10 offset:31232
v_lshl_add_u32 v222, v223, 2, v222
v_bfe_u32 v223, v1, 2, 1
v_mfma_f32_32x32x16_bf16 v[148:163], v[24:27], a[200:203], v[148:163]
ds_read_b64_tr_b16 v[44:45], v10 offset:32768
v_lshl_add_u32 v222, v223, 3, v222
v_bfe_u32 v223, v1, 4, 1
v_mfma_f32_32x32x16_bf16 v[164:179], v[24:27], a[204:207], v[164:179]
ds_read_b64_tr_b16 v[46:47], v10 offset:33280
ds_read_b64_tr_b16 v[48:49], v10 offset:34816
v_cmp_eq_u32 vcc, 1, v223
s_nop 1
v_cndmask_b32_e64 v222, v222, 16, vcc
v_mfma_f32_32x32x16_bf16 v[148:163], v[28:31], a[208:211], v[148:163]
ds_read_b64_tr_b16 v[50:51], v10 offset:35328
v_lshlrev_b32 v222, 6, v222
v_lshrrev_b32 v223, 5, v1
v_lshl_add_u32 v236, v223, 4, v222
v_mfma_f32_32x32x16_bf16 v[164:179], v[28:31], a[212:215], v[164:179]
s_and_b32 s66, s29, 1
s_mul_i32 s67, s66, 2560
v_mfma_f32_32x32x16_bf16 v[148:163], v[32:35], a[216:219], v[148:163]
s_add_u32 s67, s67, 8192
v_add_u32 v236, s67, v236
v_mfma_f32_32x32x16_bf16 v[164:179], v[32:35], a[220:223], v[164:179]
s_waitcnt lgkmcnt(0)
s_barrier
s_cmp_eq_u32 s29, 0
s_cbranch_scc0 L_A_nopoll0
s_lshl_b32 s52, s28, 8
v_mov_b32 v182, s52
global_load_dword v183, v182, s[24:25] sc1
L_A_nopoll0:
v_mfma_f32_32x32x16_bf16 v[148:163], v[36:39], a[224:227], v[148:163]
s_lshl_b32 s67, s28, 2
s_lshl_b32 s66, s66, 1
v_mfma_f32_32x32x16_bf16 v[164:179], v[36:39], a[228:231], v[164:179]
s_add_u32 s66, s66, s67
s_lshl_b32 s66, s66, 10
v_mfma_f32_32x32x16_bf16 v[148:163], v[40:43], a[232:235], v[148:163]
v_lshlrev_b32 v237, 4, v1
v_mfma_f32_32x32x16_bf16 v[164:179], v[40:43], a[236:239], v[164:179]
v_add_u32 v237, s66, v237
s_lshl_b32 s60, s27, 17
v_mfma_f32_32x32x16_bf16 v[148:163], v[44:47], a[240:243], v[148:163]
s_lshr_b32 s67, s29, 1
v_mfma_f32_32x32x16_bf16 v[164:179], v[44:47], a[244:247], v[164:179]
s_lshl_b32 s67, s67, 16
s_add_u32 s60, s60, s67
v_mfma_f32_32x32x16_bf16 v[148:163], v[48:51], a[248:251], v[148:163]
s_add_u32 s60, s60, 0x100000
v_mfma_f32_32x32x16_bf16 v[164:179], v[48:51], a[252:255], v[164:179]
s_waitcnt lgkmcnt(0)
s_cmp_eq_u32 s29, 0
s_cbranch_scc0 L_A_nopoll
s_waitcnt vmcnt(0)
v_readfirstlane_b32 s57, v183
s_nop 3
s_cmp_ge_u32 s57, 16
s_cbranch_scc1 L_ok_cnt16
s_mov_b32 s56, 0
L_spin_cnt16:
global_load_dword v183, v182, s[24:25] sc1
s_waitcnt vmcnt(0)
v_readfirstlane_b32 s57, v183
s_add_u32 s56, s56, 1
s_cmp_ge_u32 s56, 0xf4240
s_cbranch_scc1 L_spun_cnt16
s_nop 0
s_cmp_lt_u32 s57, 16
s_cbranch_scc1 L_spin_cnt16
L_spun_cnt16:
L_ok_cnt16:
v_lshlrev_b32 v18, 4, v1
s_lshl_b32 s52, s28, 2
s_mul_i32 s52, s52, 1280
s_add_u32 s52, s52, 0x4000
s_mov_b32 m0, 8192
s_nop 0
buffer_load_dwordx4 v18, s[44:47], s52 offen sc1 lds
s_mov_b64 exec, 0xf
s_add_u32 s53, s52, 1024
s_mov_b32 m0, 9216
s_nop 0
buffer_load_dwordx4 v18, s[44:47], s53 offen sc1 lds
s_mov_b64 exec, -1
s_add_u32 s52, s52, 1280
s_mov_b32 m0, 9472
s_nop 0
buffer_load_dwordx4 v18, s[44:47], s52 offen sc1 lds
s_mov_b64 exec, 0xf
s_add_u32 s53, s52, 1024
s_mov_b32 m0, 10496
s_nop 0
buffer_load_dwordx4 v18, s[44:47], s53 offen sc1 lds
s_mov_b64 exec, -1
s_add_u32 s52, s52, 1280
s_mov_b32 m0, 10752
s_nop 0
buffer_load_dwordx4 v18, s[44:47], s52 offen sc1 lds
s_mov_b64 exec, 0xf
s_add_u32 s53, s52, 1024
s_mov_b32 m0, 11776
s_nop 0
buffer_load_dwordx4 v18, s[44:47], s53 offen sc1 lds
s_mov_b64 exec, -1
s_add_u32 s52, s52, 1280
s_mov_b32 m0, 12032
s_nop 0
buffer_load_dwordx4 v18, s[44:47], s52 offen sc1 lds
s_mov_b64 exec, 0xf
s_add_u32 s53, s52, 1024
s_mov_b32 m0, 13056
s_nop 0
buffer_load_dwordx4 v18, s[44:47], s53 offen sc1 lds
s_mov_b64 exec, -1
L_A_nopoll:
s_nop 7
v_pk_fma_f32 v[216:217], v[148:149], s[54:55], v[220:221]
v_pk_fma_f32 v[218:219], v[150:151], s[54:55], v[220:221]
v_exp_f32_e64 v216, v216 clamp
v_exp_f32_e64 v217, v217 clamp
v_exp_f32_e64 v218, v218 clamp
v_exp_f32_e64 v219, v219 clamp
v_max_f32 v148, s58, v148
v_max_f32 v149, s58, v149
v_max_f32 v150, s58, v150
v_max_f32 v151, s58, v151
v_pk_add_f32 v[148:149], v[148:149], v[216:217]
v_pk_add_f32 v[150:151], v[150:151], v[218:219]
v_cvt_pk_bf16_f32 v20, v148, v149
v_cvt_pk_bf16_f32 v21, v150, v151
v_pk_fma_f32 v[228:229], v[152:153], s[54:55], v[220:221]
v_pk_fma_f32 v[230:231], v[154:155], s[54:55], v[220:221]
v_exp_f32_e64 v228, v228 clamp
v_exp_f32_e64 v229, v229 clamp
v_exp_f32_e64 v230, v230 clamp
v_exp_f32_e64 v231, v231 clamp
v_max_f32 v152, s58, v152
v_max_f32 v153, s58, v153
v_max_f32 v154, s58, v154
v_max_f32 v155, s58, v155
v_pk_add_f32 v[152:153], v[152:153], v[228:229]
v_pk_add_f32 v[154:155], v[154:155], v[230:231]
v_cvt_pk_bf16_f32 v22, v152, v153
v_cvt_pk_bf16_f32 v23, v154, v155
v_pk_fma_f32 v[216:217], v[156:157], s[54:55], v[220:221]
v_pk_fma_f32 v[218:219], v[158:159], s[54:55], v[220:221]
v_exp_f32_e64 v216, v216 clamp
v_exp_f32_e64 v217, v217 clamp
v_exp_f32_e64 v218, v218 clamp
v_exp_f32_e64 v219, v219 clamp
v_max_f32 v156, s58, v156
v_max_f32 v157, s58, v157
v_max_f32 v158, s58, v158
v_max_f32 v159, s58, v159
v_pk_add_f32 v[156:157], v[156:157], v[216:217]
v_pk_add_f32 v[158:159], v[158:159], v[218:219]
v_cvt_pk_bf16_f32 v24, v156, v157
v_cvt_pk_bf16_f32 v25, v158, v159
v_pk_fma_f32 v[228:229], v[160:161], s[54:55], v[220:221]
v_pk_fma_f32 v[230:231], v[162:163], s[54:55], v[220:221]
v_exp_f32_e64 v228, v228 clamp
v_exp_f32_e64 v229, v229 clamp
v_exp_f32_e64 v230, v230 clamp
v_exp_f32_e64 v231, v231 clamp
v_max_f32 v160, s58, v160
v_max_f32 v161, s58, v161
v_max_f32 v162, s58, v162
v_max_f32 v163, s58, v163
v_pk_add_f32 v[160:161], v[160:161], v[228:229]
v_pk_add_f32 v[162:163], v[162:163], v[230:231]
v_cvt_pk_bf16_f32 v26, v160, v161
v_cvt_pk_bf16_f32 v27, v162, v163
v_pk_fma_f32 v[216:217], v[164:165], s[54:55], v[220:221]
v_pk_fma_f32 v[218:219], v[166:167], s[54:55], v[220:221]
v_exp_f32_e64 v216, v216 clamp
v_exp_f32_e64 v217, v217 clamp
v_exp_f32_e64 v218, v218 clamp
v_exp_f32_e64 v219, v219 clamp
v_max_f32 v164, s58, v164
v_max_f32 v165, s58, v165
v_max_f32 v166, s58, v166
v_max_f32 v167, s58, v167
v_pk_add_f32 v[164:165], v[164:165], v[216:217]
v_pk_add_f32 v[166:167], v[166:167], v[218:219]
v_cvt_pk_bf16_f32 v28, v164, v165
v_cvt_pk_bf16_f32 v29, v166, v167
v_pk_fma_f32 v[228:229], v[168:169], s[54:55], v[220:221]
v_pk_fma_f32 v[230:231], v[170:171], s[54:55], v[220:221]
v_exp_f32_e64 v228, v228 clamp
v_exp_f32_e64 v229, v229 clamp
v_exp_f32_e64 v230, v230 clamp
v_exp_f32_e64 v231, v231 clamp
v_max_f32 v168, s58, v168
v_max_f32 v169, s58, v169
v_max_f32 v170, s58, v170
v_max_f32 v171, s58, v171
v_pk_add_f32 v[168:169], v[168:169], v[228:229]
v_pk_add_f32 v[170:171], v[170:171], v[230:231]
v_cvt_pk_bf16_f32 v30, v168, v169
v_cvt_pk_bf16_f32 v31, v170, v171
v_pk_fma_f32 v[216:217], v[172:173], s[54:55], v[220:221]
v_pk_fma_f32 v[218:219], v[174:175], s[54:55], v[220:221]
v_exp_f32_e64 v216, v216 clamp
v_exp_f32_e64 v217, v217 clamp
v_exp_f32_e64 v218, v218 clamp
v_exp_f32_e64 v219, v219 clamp
v_max_f32 v172, s58, v172
v_max_f32 v173, s58, v173
v_max_f32 v174, s58, v174
v_max_f32 v175, s58, v175
v_pk_add_f32 v[172:173], v[172:173], v[216:217]
v_pk_add_f32 v[174:175], v[174:175], v[218:219]
v_cvt_pk_bf16_f32 v32, v172, v173
v_cvt_pk_bf16_f32 v33, v174, v175
v_pk_fma_f32 v[228:229], v[176:177], s[54:55], v[220:221]
v_pk_fma_f32 v[230:231], v[178:179], s[54:55], v[220:221]
v_exp_f32_e64 v228, v228 clamp
v_exp_f32_e64 v229, v229 clamp
v_exp_f32_e64 v230, v230 clamp
v_exp_f32_e64 v231, v231 clamp
v_max_f32 v176, s58, v176
v_max_f32 v177, s58, v177
v_max_f32 v178, s58, v178
v_max_f32 v179, s58, v179
v_pk_add_f32 v[176:177], v[176:177], v[228:229]
v_pk_add_f32 v[178:179], v[178:179], v[230:231]
v_cvt_pk_bf16_f32 v34, v176, v177
v_cvt_pk_bf16_f32 v35, v178, v179
s_waitcnt vmcnt(0)
s_barrier
ds_read_b128 v[36:39], v236 offset:0
ds_read_b128 v[40:43], v236 offset:32
ds_read_b128 v[44:47], v236 offset:1280
ds_read_b128 v[48:51], v236 offset:1312
s_waitcnt lgkmcnt(2)
v_cvt_pk_bf16_f32 v68, v36, v37
v_cvt_pk_bf16_f32 v69, v38, v39
v_cvt_pk_bf16_f32 v70, v40, v41
v_cvt_pk_bf16_f32 v71, v42, v43
s_nop 1
v_mfma_f32_32x32x16_bf16 v[84:99], v[68:71], v[20:23], 0
v_mfma_f32_32x32x16_bf16 v[116:131], v[68:71], v[28:31], 0
s_waitcnt lgkmcnt(0)
v_cvt_pk_bf16_f32 v72, v44, v45
v_cvt_pk_bf16_f32 v73, v46, v47
v_cvt_pk_bf16_f32 v74, v48, v49
v_cvt_pk_bf16_f32 v75, v50, v51
s_nop 1
v_mfma_f32_32x32x16_bf16 v[100:115], v[72:75], v[24:27], 0
v_mfma_f32_32x32x16_bf16 v[132:147], v[72:75], v[32:35], 0
s_nop 1
v_add_f32 v92, s58, v92
v_rcp_f32 v92, v92
s_nop 0
v_pk_mul_f32 v[84:85], v[84:85], v[92:93] op_sel_hi:[1,0]
v_pk_mul_f32 v[86:87], v[86:87], v[92:93] op_sel_hi:[1,0]
v_pk_mul_f32 v[88:89], v[88:89], v[92:93] op_sel_hi:[1,0]
v_pk_mul_f32 v[90:91], v[90:91], v[92:93] op_sel_hi:[1,0]
v_cvt_pk_bf16_f32 v184, v84, v85
v_cvt_pk_bf16_f32 v185, v86, v87
v_cvt_pk_bf16_f32 v186, v88, v89
v_cvt_pk_bf16_f32 v187, v90, v91
s_add_u32 s54, s60, 0
buffer_store_dwordx4 v[184:187], v237, s[44:47], s54 offen offset:0 sc1
v_add_f32 v124, s58, v124
v_rcp_f32 v124, v124
s_nop 0
v_pk_mul_f32 v[116:117], v[116:117], v[124:125] op_sel_hi:[1,0]
v_pk_mul_f32 v[118:119], v[118:119], v[124:125] op_sel_hi:[1,0]
v_pk_mul_f32 v[120:121], v[120:121], v[124:125] op_sel_hi:[1,0]
v_pk_mul_f32 v[122:123], v[122:123], v[124:125] op_sel_hi:[1,0]
v_cvt_pk_bf16_f32 v192, v116, v117
v_cvt_pk_bf16_f32 v193, v118, v119
v_cvt_pk_bf16_f32 v194, v120, v121
v_cvt_pk_bf16_f32 v195, v122, v123
s_add_u32 s54, s60, 32768
buffer_store_dwordx4 v[192:195], v237, s[44:47], s54 offen offset:0 sc1
v_add_f32 v108, s58, v108
v_rcp_f32 v108, v108
s_nop 0
v_pk_mul_f32 v[100:101], v[100:101], v[108:109] op_sel_hi:[1,0]
v_pk_mul_f32 v[102:103], v[102:103], v[108:109] op_sel_hi:[1,0]
v_pk_mul_f32 v[104:105], v[104:105], v[108:109] op_sel_hi:[1,0]
v_pk_mul_f32 v[106:107], v[106:107], v[108:109] op_sel_hi:[1,0]
v_cvt_pk_bf16_f32 v188, v100, v101
v_cvt_pk_bf16_f32 v189, v102, v103
v_cvt_pk_bf16_f32 v190, v104, v105
v_cvt_pk_bf16_f32 v191, v106, v107
s_add_u32 s54, s60, 0
buffer_store_dwordx4 v[188:191], v237, s[44:47], s54 offen offset:1024 sc1
v_add_f32 v140, s58, v140
v_rcp_f32 v140, v140
s_nop 0
v_pk_mul_f32 v[132:133], v[132:133], v[140:141] op_sel_hi:[1,0]
v_pk_mul_f32 v[134:135], v[134:135], v[140:141] op_sel_hi:[1,0]
v_pk_mul_f32 v[136:137], v[136:137], v[140:141] op_sel_hi:[1,0]
v_pk_mul_f32 v[138:139], v[138:139], v[140:141] op_sel_hi:[1,0]
v_cvt_pk_bf16_f32 v196, v132, v133
v_cvt_pk_bf16_f32 v197, v134, v135
v_cvt_pk_bf16_f32 v198, v136, v137
v_cvt_pk_bf16_f32 v199, v138, v139
s_add_u32 s54, s60, 32768
buffer_store_dwordx4 v[196:199], v237, s[44:47], s54 offen offset:1024 sc1
s_lshl_b32 s52, s30, 7
s_lshl_b32 s53, s29, 5
s_add_u32 s52, s52, s53
s_lshl_b32 s74, s52, 11
s_mov_b32 s75, 11
s_waitcnt vmcnt(0)
s_barrier
s_cmp_eq_u32 s29, 0
s_cbranch_scc0 L_nosig8_0
s_lshl_b32 s59, s27, 8
s_add_u32 s59, s59, 0x1000
v_mov_b32 v8, s59
v_mov_b32 v9, 1
s_mov_b64 exec, 1
global_atomic_add v8, v9, s[24:25] sc1
s_mov_b64 exec, -1
L_nosig8_0:
s_branch L_P2
L_B:
s_mov_b32 s34, 0x200000
s_mov_b32 s35, 0x20000
s_mov_b32 s38, 0x180000
s_mov_b32 s39, 0x20000
s_lshl_b32 s71, s29, 12
s_lshl_b32 s72, s29, 9
s_add_u32 s72, s72, 16384
s_lshl_b32 s73, s29, 11
s_add_u32 s73, s73, 18432
s_xor_b32 s57, s27, s28
s_and_b32 s57, s57, 1
s_lshl_b32 s57, s57, 2
s_and_b32 s56, s2, 3
s_add_u32 s57, s57, s56
s_and_b32 s57, s57, 7
s_lshl_b32 s60, s57, 7
s_mul_i32 s61, s57, 0x30000
s_lshl_b32 s52, s27, 7
s_and_b32 s53, s29, 1
s_lshr_b32 s54, s29, 1
s_lshl_b32 s55, s53, 6
s_add_u32 s55, s55, s54
s_add_u32 s55, s55, s52
s_lshl_b32 s55, s55, 10
v_lshlrev_b32 v17, 11, v16
v_xor_b32 v19, v20, v18
v_lshlrev_b32 v19, 4, v19
v_add3_u32 v2, v17, v19, s55
v_xor_b32 v3, 64, v2
v_add_u32 v4, 30720, v2
v_add_u32 v5, 46080, v3
v_add_u32 v3, 15360, v3
s_lshl_b32 s55, s53, 3
s_add_u32 s55, s55, s54
s_add_u32 s55, s55, s52
s_sub_u32 s55, s55, 16
s_lshl_b32 s55, s55, 10
s_lshl_b32 s56, s29, 1
v_add_u32 v19, s56, v18
v_and_b32 v19, 7, v19
v_xor_b32 v19, v19, v20
v_lshlrev_b32 v19, 4, v19
v_add3_u32 v6, v17, v19, s55
s_waitcnt lgkmcnt(0)
s_mov_b32 s36, s16
s_mov_b32 s37, s17
s_mov_b32 s32, s14
s_mov_b32 s33, s15
s_add_u32 m0, s73, 0x1c00
s_nop 0
buffer_load_dwordx4 v7, s[36:39], s61 offen offset:1024 lds
buffer_load_dwordx4 v8, s[36:39], s61 offen offset:2048 lds
s_add_u32 m0, s73, 0x3800
s_nop 0
buffer_load_dwordx4 v7, s[36:39], s61 offen offset:2048 lds
buffer_load_dwordx4 v8, s[36:39], s61 offen offset:3072 lds
s_add_u32 m0, s73, 0x0
s_nop 0
buffer_load_dwordx4 v7, s[36:39], s61 offen offset:0 lds
buffer_load_dwordx4 v8, s[36:39], s61 offen offset:1024 lds
s_add_u32 s61, s61, 0x30000
s_cmp_eq_u32 s61, 0x180000
s_cselect_b32 s61, 0, s61
s_add_u32 m0, s71, 0x0
s_nop 0
buffer_load_dwordx4 v2, s[32:35], s60 offen lds
buffer_load_dwordx4 v3, s[32:35], s60 offen offset:1024 lds
buffer_load_dwordx4 v4, s[32:35], s60 offen offset:2048 lds
buffer_load_dwordx4 v5, s[32:35], s60 offen offset:3072 lds
s_add_u32 m0, s72, 0x0
s_mov_b64 exec, 0xffffffff
buffer_load_dwordx4 v6, s[32:35], s60 offen lds
s_mov_b64 exec, -1
s_add_u32 s60, s60, 128
s_and_b32 s60, s60, 1023
s_mov_b32 s44, s24
s_mov_b32 s45, s25
s_mov_b32 s46, 0x800000
s_mov_b32 s47, 0x20000
s_cmp_ge_u32 s2, 16
s_cbranch_scc1 L_nozero_3
v_mov_b32 v24, 0
v_mov_b32 v25, 0
v_mov_b32 v26, 0
v_mov_b32 v27, 0
v_lshlrev_b32 v22, 4, v1
s_lshl_b32 s52, s2, 12
s_lshl_b32 s53, s29, 10
s_add_u32 s52, s52, s53
buffer_store_dwordx4 v[24:27], v22, s[44:47], s52 offen sc1
L_nozero_3:
v_lshlrev_b32 v9, 10, v18
s_add_u32 m0, s73, 0xc400
s_nop 0
buffer_load_dwordx4 v7, s[36:39], s61 offen offset:1024 lds
v_bfe_u32 v21, v1, 2, 2
buffer_load_dwordx4 v8, s[36:39], s61 offen offset:2048 lds
v_lshl_add_u32 v9, v21, 7, v9
s_add_u32 m0, s73, 0xe000
s_nop 0
buffer_load_dwordx4 v7, s[36:39], s61 offen offset:2048 lds
v_and_b32 v21, 3, v1
v_lshl_add_u32 v9, v21, 3, v9
buffer_load_dwordx4 v8, s[36:39], s61 offen offset:3072 lds
v_bfe_u32 v21, v1, 3, 2
s_add_u32 m0, s73, 0xa800
s_nop 0
buffer_load_dwordx4 v7, s[36:39], s61 offen offset:0 lds
v_lshl_add_u32 v9, v21, 5, v9
buffer_load_dwordx4 v8, s[36:39], s61 offen offset:1024 lds
s_add_u32 s61, s61, 0x30000
s_cmp_eq_u32 s61, 0x180000
s_cselect_b32 s61, 0, s61
v_and_b32 v21, 15, v1
v_lshlrev_b32 v10, 7, v21
s_add_u32 m0, s71, 0xa800
s_nop 0
buffer_load_dwordx4 v2, s[32:35], s60 offen lds
v_bfe_u32 v22, v1, 1, 3
buffer_load_dwordx4 v3, s[32:35], s60 offen offset:1024 lds
v_xor_b32 v22, v22, v18
buffer_load_dwordx4 v4, s[32:35], s60 offen offset:2048 lds
v_lshl_add_u32 v10, v22, 4, v10
v_xor_b32 v11, 64, v10
buffer_load_dwordx4 v5, s[32:35], s60 offen offset:3072 lds
s_lshl_b32 s57, s29, 5
s_add_u32 m0, s72, 0xa800
s_mov_b64 exec, 0xffffffff
buffer_load_dwordx4 v6, s[32:35], s60 offen lds
s_mov_b64 exec, -1
s_add_u32 s60, s60, 128
s_and_b32 s60, s60, 1023
v_xor_b32 v12, s57, v9
v_add_u32 v12, 18432, v12
s_mov_b32 s40, s18
s_mov_b32 s41, s19
s_mov_b32 s42, 0x80000
s_mov_b32 s43, 0x20000
s_mov_b32 s64, 0
s_mov_b32 s65, 43008
s_mov_b32 s66, 86016
v_mov_b32 v13, v11
v_mov_b32 v14, v12
s_mov_b32 s74, 0
s_waitcnt vmcnt(11)
s_barrier
ds_read_b64_tr_b16 v[56:57], v12 offset:0
ds_read_b64_tr_b16 v[58:59], v12 offset:512
ds_read_b64_tr_b16 v[60:61], v12 offset:8192
ds_read_b64_tr_b16 v[62:63], v12 offset:8704
ds_read_b64_tr_b16 v[64:65], v12 offset:16384
ds_read_b64_tr_b16 v[66:67], v12 offset:16896
ds_read_b128 v[20:23], v10 offset:0
ds_read_b128 v[24:27], v10 offset:2048
ds_read_b128 v[28:31], v10 offset:4096
ds_read_b128 v[32:35], v10 offset:6144
ds_read_b128 v[36:39], v10 offset:8192
ds_read_b128 v[40:43], v10 offset:10240
ds_read_b128 v[44:47], v10 offset:12288
ds_read_b128 v[48:51], v10 offset:14336
ds_read_b128 v[52:55], v10 offset:16384
s_waitcnt lgkmcnt(0)
v_mfma_f32_16x16x32_bf16 v[116:119], v[56:59], v[20:23], 0
ds_read_b64_tr_b16 v[104:105], v14 offset:4096
s_add_u32 s67, s66, s71
v_mfma_f32_16x16x32_bf16 v[148:151], v[60:63], v[20:23], 0
ds_read_b64_tr_b16 v[106:107], v14 offset:4608
s_add_u32 s68, s66, s72
v_mfma_f32_16x16x32_bf16 v[184:187], v[20:23], v[64:67], 0
ds_read_b64_tr_b16 v[108:109], v14 offset:12288
s_add_u32 m0, s73, 0x16c00
v_mfma_f32_16x16x32_bf16 v[120:123], v[56:59], v[24:27], 0
ds_read_b64_tr_b16 v[110:111], v14 offset:12800
buffer_load_dwordx4 v7, s[36:39], s61 offen offset:1024 lds
v_mfma_f32_16x16x32_bf16 v[152:155], v[60:63], v[24:27], 0
ds_read_b64_tr_b16 v[112:113], v14 offset:20480
buffer_load_dwordx4 v8, s[36:39], s61 offen offset:2048 lds
v_mfma_f32_16x16x32_bf16 v[188:191], v[24:27], v[64:67], 0
ds_read_b64_tr_b16 v[114:115], v14 offset:20992
s_add_u32 m0, s73, 0x18800
v_mfma_f32_16x16x32_bf16 v[124:127], v[56:59], v[28:31], 0
ds_read_b128 v[68:71], v13 offset:0
buffer_load_dwordx4 v7, s[36:39], s61 offen offset:2048 lds
v_mfma_f32_16x16x32_bf16 v[156:159], v[60:63], v[28:31], 0
ds_read_b128 v[72:75], v13 offset:2048
buffer_load_dwordx4 v8, s[36:39], s61 offen offset:3072 lds
v_mfma_f32_16x16x32_bf16 v[192:195], v[28:31], v[64:67], 0
ds_read_b128 v[76:79], v13 offset:4096
s_add_u32 m0, s73, 0x15000
v_mfma_f32_16x16x32_bf16 v[128:131], v[56:59], v[32:35], 0
ds_read_b128 v[80:83], v13 offset:6144
buffer_load_dwordx4 v7, s[36:39], s61 offen offset:0 lds
v_mfma_f32_16x16x32_bf16 v[160:163], v[60:63], v[32:35], 0
ds_read_b128 v[84:87], v13 offset:8192
buffer_load_dwordx4 v8, s[36:39], s61 offen offset:1024 lds
v_mfma_f32_16x16x32_bf16 v[196:199], v[32:35], v[64:67], 0
ds_read_b128 v[88:91], v13 offset:10240
s_add_u32 s61, s61, 0x30000
v_mfma_f32_16x16x32_bf16 v[132:135], v[56:59], v[36:39], 0
ds_read_b128 v[92:95], v13 offset:12288
v_add_u32 v15, s65, v10
v_mfma_f32_16x16x32_bf16 v[164:167], v[60:63], v[36:39], 0
ds_read_b128 v[96:99], v13 offset:14336
v_add_u32 v16, s65, v12
v_mfma_f32_16x16x32_bf16 v[200:203], v[36:39], v[64:67], 0
ds_read_b128 v[100:103], v13 offset:16384
s_add_u32 s69, s64, s73
v_mfma_f32_16x16x32_bf16 v[136:139], v[56:59], v[40:43], 0
s_cmp_eq_u32 s61, 0x180000
s_cselect_b32 s61, 0, s61
v_mfma_f32_16x16x32_bf16 v[168:171], v[60:63], v[40:43], 0
s_add_u32 m0, s67, 0x0
s_nop 0
buffer_load_dwordx4 v2, s[32:35], s60 offen lds
v_mfma_f32_16x16x32_bf16 v[204:207], v[40:43], v[64:67], 0
buffer_load_dwordx4 v3, s[32:35], s60 offen offset:1024 lds
buffer_load_dwordx4 v4, s[32:35], s60 offen offset:2048 lds
v_mfma_f32_16x16x32_bf16 v[140:143], v[56:59], v[44:47], 0
buffer_load_dwordx4 v5, s[32:35], s60 offen offset:3072 lds
s_add_u32 m0, s68, 0x0
v_mfma_f32_16x16x32_bf16 v[172:175], v[60:63], v[44:47], 0
s_mov_b64 exec, 0xffffffff
buffer_load_dwordx4 v6, s[32:35], s60 offen lds
s_mov_b64 exec, -1
v_mfma_f32_16x16x32_bf16 v[208:211], v[44:47], v[64:67], 0
s_add_u32 s60, s60, 128
v_mfma_f32_16x16x32_bf16 v[144:147], v[56:59], v[48:51], 0
s_and_b32 s60, s60, 1023
v_mfma_f32_16x16x32_bf16 v[176:179], v[60:63], v[48:51], 0
v_mfma_f32_16x16x32_bf16 v[212:215], v[48:51], v[64:67], 0
v_mfma_f32_16x16x32_bf16 v[180:183], v[60:63], v[52:55], 0
v_mfma_f32_16x16x32_bf16 v[216:219], v[52:55], v[64:67], 0
s_waitcnt lgkmcnt(0)
s_waitcnt vmcnt(11)
s_barrier
s_cmp_ge_u32 s2, 16
s_cbranch_scc1 L_nosigz_4
s_cmp_eq_u32 s29, 0
s_cbranch_scc0 L_nosigz_4
v_mov_b32 v244, 0
v_mov_b32 v245, 1
s_mov_b64 exec, 1
global_atomic_add v244, v245, s[22:23] sc1
s_mov_b64 exec, -1
L_nosigz_4:
v_mfma_f32_16x16x32_bf16 v[116:119], v[104:107], v[68:71], v[116:119]
ds_read_b64_tr_b16 v[56:57], v16 offset:0
s_add_u32 m0, s69, 0x1c00
v_mfma_f32_16x16x32_bf16 v[148:151], v[108:111], v[68:71], v[148:151]
ds_read_b64_tr_b16 v[58:59], v16 offset:512
v_mfma_f32_16x16x32_bf16 v[184:187], v[68:71], v[112:115], v[184:187]
ds_read_b64_tr_b16 v[60:61], v16 offset:8192
buffer_load_dwordx4 v7, s[36:39], s61 offen offset:1024 lds
v_mfma_f32_16x16x32_bf16 v[120:123], v[104:107], v[72:75], v[120:123]
ds_read_b64_tr_b16 v[62:63], v16 offset:8704
v_mfma_f32_16x16x32_bf16 v[152:155], v[108:111], v[72:75], v[152:155]
ds_read_b64_tr_b16 v[64:65], v16 offset:16384
buffer_load_dwordx4 v8, s[36:39], s61 offen offset:2048 lds
v_mfma_f32_16x16x32_bf16 v[188:191], v[72:75], v[112:115], v[188:191]
ds_read_b64_tr_b16 v[66:67], v16 offset:16896
v_mfma_f32_16x16x32_bf16 v[124:127], v[104:107], v[76:79], v[124:127]
ds_read_b128 v[20:23], v15 offset:0
s_add_u32 m0, s69, 0x3800
v_mfma_f32_16x16x32_bf16 v[156:159], v[108:111], v[76:79], v[156:159]
ds_read_b128 v[24:27], v15 offset:2048
v_mfma_f32_16x16x32_bf16 v[192:195], v[76:79], v[112:115], v[192:195]
ds_read_b128 v[28:31], v15 offset:4096
buffer_load_dwordx4 v7, s[36:39], s61 offen offset:2048 lds
v_mfma_f32_16x16x32_bf16 v[128:131], v[104:107], v[80:83], v[128:131]
ds_read_b128 v[32:35], v15 offset:6144
v_mfma_f32_16x16x32_bf16 v[160:163], v[108:111], v[80:83], v[160:163]
ds_read_b128 v[36:39], v15 offset:8192
buffer_load_dwordx4 v8, s[36:39], s61 offen offset:3072 lds
v_mfma_f32_16x16x32_bf16 v[196:199], v[80:83], v[112:115], v[196:199]
ds_read_b128 v[40:43], v15 offset:10240
v_mfma_f32_16x16x32_bf16 v[132:135], v[104:107], v[84:87], v[132:135]
ds_read_b128 v[44:47], v15 offset:12288
s_add_u32 m0, s69, 0x0
v_mfma_f32_16x16x32_bf16 v[164:167], v[108:111], v[84:87], v[164:167]
ds_read_b128 v[48:51], v15 offset:14336
v_add_u32 v13, s65, v11
v_mfma_f32_16x16x32_bf16 v[200:203], v[84:87], v[112:115], v[200:203]
ds_read_b128 v[52:55], v15 offset:16384
buffer_load_dwordx4 v7, s[36:39], s61 offen offset:0 lds
v_mfma_f32_16x16x32_bf16 v[136:139], v[104:107], v[88:91], v[136:139]
v_mov_b32 v14, v16
s_mov_b32 s53, s64
v_mfma_f32_16x16x32_bf16 v[168:171], v[108:111], v[88:91], v[168:171]
buffer_load_dwordx4 v8, s[36:39], s61 offen offset:1024 lds
v_mfma_f32_16x16x32_bf16 v[204:207], v[88:91], v[112:115], v[204:207]
s_mov_b32 s64, s65
v_mfma_f32_16x16x32_bf16 v[140:143], v[104:107], v[92:95], v[140:143]
s_add_u32 s61, s61, 0x30000
s_mov_b32 s65, s66
v_mfma_f32_16x16x32_bf16 v[172:175], v[108:111], v[92:95], v[172:175]
v_mfma_f32_16x16x32_bf16 v[208:211], v[92:95], v[112:115], v[208:211]
s_cmp_eq_u32 s61, 0x180000
s_cselect_b32 s61, 0, s61
v_mfma_f32_16x16x32_bf16 v[144:147], v[104:107], v[96:99], v[144:147]
s_mov_b32 s66, s53
v_mfma_f32_16x16x32_bf16 v[176:179], v[108:111], v[96:99], v[176:179]
v_mfma_f32_16x16x32_bf16 v[212:215], v[96:99], v[112:115], v[212:215]
v_mfma_f32_16x16x32_bf16 v[180:183], v[108:111], v[100:103], v[180:183]
v_mfma_f32_16x16x32_bf16 v[216:219], v[100:103], v[112:115], v[216:219]
s_waitcnt lgkmcnt(0)
L_Bloop:
v_mfma_f32_16x16x32_bf16 v[116:119], v[56:59], v[20:23], v[116:119]
ds_read_b64_tr_b16 v[104:105], v14 offset:4096
s_add_u32 s67, s66, s71
v_mfma_f32_16x16x32_bf16 v[148:151], v[60:63], v[20:23], v[148:151]
ds_read_b64_tr_b16 v[106:107], v14 offset:4608
v_mfma_f32_16x16x32_bf16 v[184:187], v[20:23], v[64:67], v[184:187]
ds_read_b64_tr_b16 v[108:109], v14 offset:12288
s_add_u32 s68, s66, s72
v_mfma_f32_16x16x32_bf16 v[120:123], v[56:59], v[24:27], v[120:123]
ds_read_b64_tr_b16 v[110:111], v14 offset:12800
v_mfma_f32_16x16x32_bf16 v[152:155], v[60:63], v[24:27], v[152:155]
ds_read_b64_tr_b16 v[112:113], v14 offset:20480
s_add_u32 m0, s67, 0x0
v_mfma_f32_16x16x32_bf16 v[188:191], v[24:27], v[64:67], v[188:191]
ds_read_b64_tr_b16 v[114:115], v14 offset:20992
v_mfma_f32_16x16x32_bf16 v[124:127], v[56:59], v[28:31], v[124:127]
ds_read_b128 v[68:71], v13 offset:0
buffer_load_dwordx4 v2, s[32:35], s60 offen lds
v_mfma_f32_16x16x32_bf16 v[156:159], v[60:63], v[28:31], v[156:159]
ds_read_b128 v[72:75], v13 offset:2048
v_mfma_f32_16x16x32_bf16 v[192:195], v[28:31], v[64:67], v[192:195]
ds_read_b128 v[76:79], v13 offset:4096
buffer_load_dwordx4 v3, s[32:35], s60 offen offset:1024 lds
v_mfma_f32_16x16x32_bf16 v[128:131], v[56:59], v[32:35], v[128:131]
ds_read_b128 v[80:83], v13 offset:6144
v_mfma_f32_16x16x32_bf16 v[160:163], v[60:63], v[32:35], v[160:163]
ds_read_b128 v[84:87], v13 offset:8192
buffer_load_dwordx4 v4, s[32:35], s60 offen offset:2048 lds
v_mfma_f32_16x16x32_bf16 v[196:199], v[32:35], v[64:67], v[196:199]
ds_read_b128 v[88:91], v13 offset:10240
v_add_u32 v15, s65, v10
v_mfma_f32_16x16x32_bf16 v[132:135], v[56:59], v[36:39], v[132:135]
ds_read_b128 v[92:95], v13 offset:12288
buffer_load_dwordx4 v5, s[32:35], s60 offen offset:3072 lds
v_mfma_f32_16x16x32_bf16 v[164:167], v[60:63], v[36:39], v[164:167]
ds_read_b128 v[96:99], v13 offset:14336
v_add_u32 v16, s65, v12
v_mfma_f32_16x16x32_bf16 v[200:203], v[36:39], v[64:67], v[200:203]
ds_read_b128 v[100:103], v13 offset:16384
s_add_u32 m0, s68, 0x0
v_mfma_f32_16x16x32_bf16 v[136:139], v[56:59], v[40:43], v[136:139]
s_add_u32 s69, s64, s73
v_mfma_f32_16x16x32_bf16 v[168:171], v[60:63], v[40:43], v[168:171]
s_mov_b64 exec, 0xffffffff
buffer_load_dwordx4 v6, s[32:35], s60 offen lds
s_mov_b64 exec, -1
v_mfma_f32_16x16x32_bf16 v[204:207], v[40:43], v[64:67], v[204:207]
v_mfma_f32_16x16x32_bf16 v[140:143], v[56:59], v[44:47], v[140:143]
s_add_u32 s60, s60, 128
v_mfma_f32_16x16x32_bf16 v[172:175], v[60:63], v[44:47], v[172:175]
v_mfma_f32_16x16x32_bf16 v[208:211], v[44:47], v[64:67], v[208:211]
s_and_b32 s60, s60, 1023
v_mfma_f32_16x16x32_bf16 v[144:147], v[56:59], v[48:51], v[144:147]
v_mfma_f32_16x16x32_bf16 v[176:179], v[60:63], v[48:51], v[176:179]
v_mfma_f32_16x16x32_bf16 v[212:215], v[48:51], v[64:67], v[212:215]
v_mfma_f32_16x16x32_bf16 v[180:183], v[60:63], v[52:55], v[180:183]
v_mfma_f32_16x16x32_bf16 v[216:219], v[52:55], v[64:67], v[216:219]
s_waitcnt lgkmcnt(0)
s_waitcnt vmcnt(11)
s_barrier
v_mfma_f32_16x16x32_bf16 v[116:119], v[104:107], v[68:71], v[116:119]
ds_read_b64_tr_b16 v[56:57], v16 offset:0
s_add_u32 m0, s69, 0x1c00
v_mfma_f32_16x16x32_bf16 v[148:151], v[108:111], v[68:71], v[148:151]
ds_read_b64_tr_b16 v[58:59], v16 offset:512
v_mfma_f32_16x16x32_bf16 v[184:187], v[68:71], v[112:115], v[184:187]
ds_read_b64_tr_b16 v[60:61], v16 offset:8192
buffer_load_dwordx4 v7, s[36:39], s61 offen offset:1024 lds
v_mfma_f32_16x16x32_bf16 v[120:123], v[104:107], v[72:75], v[120:123]
ds_read_b64_tr_b16 v[62:63], v16 offset:8704
v_mfma_f32_16x16x32_bf16 v[152:155], v[108:111], v[72:75], v[152:155]
ds_read_b64_tr_b16 v[64:65], v16 offset:16384
buffer_load_dwordx4 v8, s[36:39], s61 offen offset:2048 lds
v_mfma_f32_16x16x32_bf16 v[188:191], v[72:75], v[112:115], v[188:191]
ds_read_b64_tr_b16 v[66:67], v16 offset:16896
v_mfma_f32_16x16x32_bf16 v[124:127], v[104:107], v[76:79], v[124:127]
ds_read_b128 v[20:23], v15 offset:0
s_add_u32 m0, s69, 0x3800
v_mfma_f32_16x16x32_bf16 v[156:159], v[108:111], v[76:79], v[156:159]
ds_read_b128 v[24:27], v15 offset:2048
v_mfma_f32_16x16x32_bf16 v[192:195], v[76:79], v[112:115], v[192:195]
ds_read_b128 v[28:31], v15 offset:4096
buffer_load_dwordx4 v7, s[36:39], s61 offen offset:2048 lds
v_mfma_f32_16x16x32_bf16 v[128:131], v[104:107], v[80:83], v[128:131]
ds_read_b128 v[32:35], v15 offset:6144
v_mfma_f32_16x16x32_bf16 v[160:163], v[108:111], v[80:83], v[160:163]
ds_read_b128 v[36:39], v15 offset:8192
buffer_load_dwordx4 v8, s[36:39], s61 offen offset:3072 lds
v_mfma_f32_16x16x32_bf16 v[196:199], v[80:83], v[112:115], v[196:199]
ds_read_b128 v[40:43], v15 offset:10240
v_mfma_f32_16x16x32_bf16 v[132:135], v[104:107], v[84:87], v[132:135]
ds_read_b128 v[44:47], v15 offset:12288
s_add_u32 m0, s69, 0x0
v_mfma_f32_16x16x32_bf16 v[164:167], v[108:111], v[84:87], v[164:167]
ds_read_b128 v[48:51], v15 offset:14336
v_add_u32 v13, s65, v11
v_mfma_f32_16x16x32_bf16 v[200:203], v[84:87], v[112:115], v[200:203]
ds_read_b128 v[52:55], v15 offset:16384
buffer_load_dwordx4 v7, s[36:39], s61 offen offset:0 lds
v_mfma_f32_16x16x32_bf16 v[136:139], v[104:107], v[88:91], v[136:139]
v_mov_b32 v14, v16
s_mov_b32 s53, s64
v_mfma_f32_16x16x32_bf16 v[168:171], v[108:111], v[88:91], v[168:171]
buffer_load_dwordx4 v8, s[36:39], s61 offen offset:1024 lds
v_mfma_f32_16x16x32_bf16 v[204:207], v[88:91], v[112:115], v[204:207]
s_mov_b32 s64, s65
v_mfma_f32_16x16x32_bf16 v[140:143], v[104:107], v[92:95], v[140:143]
s_add_u32 s61, s61, 0x30000
s_mov_b32 s65, s66
v_mfma_f32_16x16x32_bf16 v[172:175], v[108:111], v[92:95], v[172:175]
v_mfma_f32_16x16x32_bf16 v[208:211], v[92:95], v[112:115], v[208:211]
s_cmp_eq_u32 s61, 0x180000
s_cselect_b32 s61, 0, s61
v_mfma_f32_16x16x32_bf16 v[144:147], v[104:107], v[96:99], v[144:147]
s_mov_b32 s66, s53
v_mfma_f32_16x16x32_bf16 v[176:179], v[108:111], v[96:99], v[176:179]
v_mfma_f32_16x16x32_bf16 v[212:215], v[96:99], v[112:115], v[212:215]
v_mfma_f32_16x16x32_bf16 v[180:183], v[108:111], v[100:103], v[180:183]
v_mfma_f32_16x16x32_bf16 v[216:219], v[100:103], v[112:115], v[216:219]
s_add_u32 s74, s74, 1
s_cmp_lt_u32 s74, 4
s_waitcnt lgkmcnt(0)
s_cbranch_scc1 L_Bloop
v_mfma_f32_16x16x32_bf16 v[116:119], v[56:59], v[20:23], v[116:119]
ds_read_b64_tr_b16 v[104:105], v14 offset:4096
s_add_u32 s67, s66, s71
v_mfma_f32_16x16x32_bf16 v[148:151], v[60:63], v[20:23], v[148:151]
ds_read_b64_tr_b16 v[106:107], v14 offset:4608
v_lshrrev_b32 v246, 3, v1
v_mfma_f32_16x16x32_bf16 v[184:187], v[20:23], v[64:67], v[184:187]
ds_read_b64_tr_b16 v[108:109], v14 offset:12288
s_add_u32 s68, s66, s72
v_mfma_f32_16x16x32_bf16 v[120:123], v[56:59], v[24:27], v[120:123]
ds_read_b64_tr_b16 v[110:111], v14 offset:12800
s_lshl_b32 s52, s29, 7
v_mfma_f32_16x16x32_bf16 v[152:155], v[60:63], v[24:27], v[152:155]
ds_read_b64_tr_b16 v[112:113], v14 offset:20480
s_add_u32 m0, s67, 0x0
v_mfma_f32_16x16x32_bf16 v[188:191], v[24:27], v[64:67], v[188:191]
ds_read_b64_tr_b16 v[114:115], v14 offset:20992
v_add_u32 v246, s52, v246
v_mfma_f32_16x16x32_bf16 v[124:127], v[56:59], v[28:31], v[124:127]
ds_read_b128 v[68:71], v13 offset:0
buffer_load_dwordx4 v2, s[32:35], s60 offen lds
v_mfma_f32_16x16x32_bf16 v[156:159], v[60:63], v[28:31], v[156:159]
ds_read_b128 v[72:75], v13 offset:2048
v_lshlrev_b32 v246, 10, v246
v_mfma_f32_16x16x32_bf16 v[192:195], v[28:31], v[64:67], v[192:195]
ds_read_b128 v[76:79], v13 offset:4096
buffer_load_dwordx4 v3, s[32:35], s60 offen offset:1024 lds
v_mfma_f32_16x16x32_bf16 v[128:131], v[56:59], v[32:35], v[128:131]
ds_read_b128 v[80:83], v13 offset:6144
v_bfe_u32 v247, v1, 4, 1
v_mfma_f32_16x16x32_bf16 v[160:163], v[60:63], v[32:35], v[160:163]
ds_read_b128 v[84:87], v13 offset:8192
buffer_load_dwordx4 v4, s[32:35], s60 offen offset:2048 lds
v_mfma_f32_16x16x32_bf16 v[196:199], v[32:35], v[64:67], v[196:199]
ds_read_b128 v[88:91], v13 offset:10240
v_add_u32 v15, s65, v10
v_mfma_f32_16x16x32_bf16 v[132:135], v[56:59], v[36:39], v[132:135]
ds_read_b128 v[92:95], v13 offset:12288
buffer_load_dwordx4 v5, s[32:35], s60 offen offset:3072 lds
v_mfma_f32_16x16x32_bf16 v[164:167], v[60:63], v[36:39], v[164:167]
ds_read_b128 v[96:99], v13 offset:14336
v_add_u32 v16, s65, v12
v_mfma_f32_16x16x32_bf16 v[200:203], v[36:39], v[64:67], v[200:203]
ds_read_b128 v[100:103], v13 offset:16384
s_add_u32 m0, s68, 0x0
v_mfma_f32_16x16x32_bf16 v[136:139], v[56:59], v[40:43], v[136:139]
v_lshlrev_b32 v247, 2, v247
v_and_b32 v248, 7, v1
v_mfma_f32_16x16x32_bf16 v[168:171], v[60:63], v[40:43], v[168:171]
s_mov_b64 exec, 0xffffffff
buffer_load_dwordx4 v6, s[32:35], s60 offen lds
s_mov_b64 exec, -1
v_mfma_f32_16x16x32_bf16 v[204:207], v[40:43], v[64:67], v[204:207]
v_xor_b32 v247, v247, v248
v_lshlrev_b32 v247, 4, v247
v_mfma_f32_16x16x32_bf16 v[140:143], v[56:59], v[44:47], v[140:143]
s_add_u32 s60, s60, 128
s_lshl_b32 s52, s31, 7
v_mfma_f32_16x16x32_bf16 v[172:175], v[60:63], v[44:47], v[172:175]
v_add3_u32 v240, v246, v247, s52
v_add_u32 v241, 7168, v240
v_mfma_f32_16x16x32_bf16 v[208:211], v[44:47], v[64:67], v[208:211]
s_and_b32 s60, s60, 1023
v_add_u32 v242, 14336, v240
v_mfma_f32_16x16x32_bf16 v[144:147], v[56:59], v[48:51], v[144:147]
v_add_u32 v243, 21504, v240
s_lshl_b32 s70, s29, 14
v_mfma_f32_16x16x32_bf16 v[176:179], v[60:63], v[48:51], v[176:179]
s_add_u32 s70, s70, 0x18000
v_mfma_f32_16x16x32_bf16 v[212:215], v[48:51], v[64:67], v[212:215]
v_mfma_f32_16x16x32_bf16 v[180:183], v[60:63], v[52:55], v[180:183]
v_mfma_f32_16x16x32_bf16 v[216:219], v[52:55], v[64:67], v[216:219]
s_waitcnt lgkmcnt(0)
s_waitcnt vmcnt(11)
s_barrier
v_mfma_f32_16x16x32_bf16 v[116:119], v[104:107], v[68:71], v[116:119]
ds_read_b64_tr_b16 v[56:57], v16 offset:0
s_lshr_b32 s58, s2, 6
v_mfma_f32_16x16x32_bf16 v[148:151], v[108:111], v[68:71], v[148:151]
ds_read_b64_tr_b16 v[58:59], v16 offset:512
v_mfma_f32_16x16x32_bf16 v[184:187], v[68:71], v[112:115], v[184:187]
ds_read_b64_tr_b16 v[60:61], v16 offset:8192
s_lshl_b32 s58, s58, 2
v_mfma_f32_16x16x32_bf16 v[120:123], v[104:107], v[72:75], v[120:123]
ds_read_b64_tr_b16 v[62:63], v16 offset:8704
v_mfma_f32_16x16x32_bf16 v[152:155], v[108:111], v[72:75], v[152:155]
ds_read_b64_tr_b16 v[64:65], v16 offset:16384
v_mfma_f32_16x16x32_bf16 v[188:191], v[72:75], v[112:115], v[188:191]
ds_read_b64_tr_b16 v[66:67], v16 offset:16896
s_add_u32 s58, s58, s29
v_mfma_f32_16x16x32_bf16 v[124:127], v[104:107], v[76:79], v[124:127]
ds_read_b128 v[20:23], v15 offset:0
v_mfma_f32_16x16x32_bf16 v[156:159], v[108:111], v[76:79], v[156:159]
ds_read_b128 v[24:27], v15 offset:2048
v_mfma_f32_16x16x32_bf16 v[192:195], v[76:79], v[112:115], v[192:195]
ds_read_b128 v[28:31], v15 offset:4096
s_lshl_b32 s58, s58, 15
v_mfma_f32_16x16x32_bf16 v[128:131], v[104:107], v[80:83], v[128:131]
ds_read_b128 v[32:35], v15 offset:6144
v_mfma_f32_16x16x32_bf16 v[160:163], v[108:111], v[80:83], v[160:163]
ds_read_b128 v[36:39], v15 offset:8192
v_mfma_f32_16x16x32_bf16 v[196:199], v[80:83], v[112:115], v[196:199]
ds_read_b128 v[40:43], v15 offset:10240
s_lshl_b32 s59, s31, 7
v_mfma_f32_16x16x32_bf16 v[132:135], v[104:107], v[84:87], v[132:135]
ds_read_b128 v[44:47], v15 offset:12288
v_add_u32 v13, s65, v11
v_mfma_f32_16x16x32_bf16 v[164:167], v[108:111], v[84:87], v[164:167]
ds_read_b128 v[48:51], v15 offset:14336
v_mov_b32 v14, v16
v_mfma_f32_16x16x32_bf16 v[200:203], v[84:87], v[112:115], v[200:203]
ds_read_b128 v[52:55], v15 offset:16384
s_add_u32 s58, s58, s59
v_mfma_f32_16x16x32_bf16 v[136:139], v[104:107], v[88:91], v[136:139]
s_mov_b32 s53, s64
v_mfma_f32_16x16x32_bf16 v[168:171], v[108:111], v[88:91], v[168:171]
v_mfma_f32_16x16x32_bf16 v[204:207], v[88:91], v[112:115], v[204:207]
v_lshlrev_b32 v9, 10, v1
s_mov_b32 s64, s65
v_mfma_f32_16x16x32_bf16 v[140:143], v[104:107], v[92:95], v[140:143]
s_mov_b32 s65, s66
v_mfma_f32_16x16x32_bf16 v[172:175], v[108:111], v[92:95], v[172:175]
v_mfma_f32_16x16x32_bf16 v[208:211], v[92:95], v[112:115], v[208:211]
s_mov_b64 exec, 0xffffffff
buffer_load_dword v17, v9, s[40:43], s58 offen
s_mov_b64 exec, -1
v_mfma_f32_16x16x32_bf16 v[144:147], v[104:107], v[96:99], v[144:147]
s_mov_b32 s66, s53
v_mfma_f32_16x16x32_bf16 v[176:179], v[108:111], v[96:99], v[176:179]
v_mfma_f32_16x16x32_bf16 v[212:215], v[96:99], v[112:115], v[212:215]
v_mfma_f32_16x16x32_bf16 v[180:183], v[108:111], v[100:103], v[180:183]
v_mfma_f32_16x16x32_bf16 v[216:219], v[100:103], v[112:115], v[216:219]
s_waitcnt lgkmcnt(0)
v_mfma_f32_16x16x32_bf16 v[116:119], v[56:59], v[20:23], v[116:119]
ds_read_b64_tr_b16 v[104:105], v14 offset:4096
v_mfma_f32_16x16x32_bf16 v[148:151], v[60:63], v[20:23], v[148:151]
ds_read_b64_tr_b16 v[106:107], v14 offset:4608
v_and_b32 v246, 15, v1
v_mfma_f32_16x16x32_bf16 v[184:187], v[20:23], v[64:67], v[184:187]
ds_read_b64_tr_b16 v[108:109], v14 offset:12288
s_mov_b32 s58, 0xf149f2ca
v_mfma_f32_16x16x32_bf16 v[120:123], v[56:59], v[24:27], v[120:123]
ds_read_b64_tr_b16 v[110:111], v14 offset:12800
v_mfma_f32_16x16x32_bf16 v[152:155], v[60:63], v[24:27], v[152:155]
ds_read_b64_tr_b16 v[112:113], v14 offset:20480
v_mfma_f32_16x16x32_bf16 v[188:191], v[24:27], v[64:67], v[188:191]
ds_read_b64_tr_b16 v[114:115], v14 offset:20992
v_mfma_f32_16x16x32_bf16 v[124:127], v[56:59], v[28:31], v[124:127]
ds_read_b128 v[68:71], v13 offset:0
v_mfma_f32_16x16x32_bf16 v[156:159], v[60:63], v[28:31], v[156:159]
ds_read_b128 v[72:75], v13 offset:2048
v_mfma_f32_16x16x32_bf16 v[192:195], v[28:31], v[64:67], v[192:195]
ds_read_b128 v[76:79], v13 offset:4096
v_mfma_f32_16x16x32_bf16 v[128:131], v[56:59], v[32:35], v[128:131]
ds_read_b128 v[80:83], v13 offset:6144
v_mfma_f32_16x16x32_bf16 v[160:163], v[60:63], v[32:35], v[160:163]
ds_read_b128 v[84:87], v13 offset:8192
v_add_u32 v15, s65, v10
v_mfma_f32_16x16x32_bf16 v[196:199], v[32:35], v[64:67], v[196:199]
ds_read_b128 v[88:91], v13 offset:10240
v_mfma_f32_16x16x32_bf16 v[132:135], v[56:59], v[36:39], v[132:135]
ds_read_b128 v[92:95], v13 offset:12288
v_mfma_f32_16x16x32_bf16 v[164:167], v[60:63], v[36:39], v[164:167]
ds_read_b128 v[96:99], v13 offset:14336
v_add_u32 v16, s65, v12
v_mfma_f32_16x16x32_bf16 v[200:203], v[36:39], v[64:67], v[200:203]
ds_read_b128 v[100:103], v13 offset:16384
v_mfma_f32_16x16x32_bf16 v[136:139], v[56:59], v[40:43], v[136:139]
s_cmp_eq_u32 s27, 0
s_cselect_b32 s63, s58, 0
v_mfma_f32_16x16x32_bf16 v[168:171], v[60:63], v[40:43], v[168:171]
v_mov_b32 v251, s58
v_lshlrev_b32 v247, 2, v18
v_mfma_f32_16x16x32_bf16 v[204:207], v[40:43], v[64:67], v[204:207]
v_add_u32 v248, 0, v247
v_sub_u32 v249, v248, v246
v_mfma_f32_16x16x32_bf16 v[140:143], v[56:59], v[44:47], v[140:143]
v_sub_u32 v250, v246, v248
v_mfma_f32_16x16x32_bf16 v[172:175], v[60:63], v[44:47], v[172:175]
v_cmp_le_i32 vcc, 9, v249
s_nop 1
v_cndmask_b32_e64 v220, v251, 0, vcc
v_mfma_f32_16x16x32_bf16 v[208:211], v[44:47], v[64:67], v[208:211]
v_cmp_ge_u32 vcc, 7, v250
s_nop 1
v_cndmask_b32_e64 v224, v251, 0, vcc
v_mfma_f32_16x16x32_bf16 v[144:147], v[56:59], v[48:51], v[144:147]
v_cmp_le_i32 vcc, 1, v249
v_cmp_ge_u32 s[54:55], 7, v248
v_mfma_f32_16x16x32_bf16 v[176:179], v[60:63], v[48:51], v[176:179]
s_nop 2
s_and_b64 vcc, vcc, s[54:55]
v_cndmask_b32_e64 v228, v251, 0, vcc
v_mfma_f32_16x16x32_bf16 v[212:215], v[48:51], v[64:67], v[212:215]
v_min_f32 v228, s63, v228
v_min_f32 v232, s63, v220
v_mfma_f32_16x16x32_bf16 v[180:183], v[60:63], v[52:55], v[180:183]
v_mov_b32 v236, 0x3f803f80
v_add_u32 v248, 1, v247
v_mfma_f32_16x16x32_bf16 v[216:219], v[52:55], v[64:67], v[216:219]
v_sub_u32 v249, v248, v246
v_sub_u32 v250, v246, v248
v_cmp_le_i32 vcc, 9, v249
s_nop 1
v_cndmask_b32_e64 v221, v251, 0, vcc
v_cmp_ge_u32 vcc, 7, v250
s_nop 1
v_cndmask_b32_e64 v225, v251, 0, vcc
v_cmp_le_i32 vcc, 1, v249
v_cmp_ge_u32 s[54:55], 7, v248
s_nop 3
s_and_b64 vcc, vcc, s[54:55]
v_cndmask_b32_e64 v229, v251, 0, vcc
v_min_f32 v229, s63, v229
s_waitcnt lgkmcnt(0)
s_waitcnt vmcnt(1)
s_barrier
v_mfma_f32_16x16x32_bf16 v[116:119], v[104:107], v[68:71], v[116:119]
ds_read_b64_tr_b16 v[56:57], v16 offset:0
s_add_u32 m0, s70, 0x0
v_mfma_f32_16x16x32_bf16 v[148:151], v[108:111], v[68:71], v[148:151]
ds_read_b64_tr_b16 v[58:59], v16 offset:512
v_min_f32 v233, s63, v221
v_mfma_f32_16x16x32_bf16 v[184:187], v[68:71], v[112:115], v[184:187]
ds_read_b64_tr_b16 v[60:61], v16 offset:8192
v_mov_b32 v237, 0x3f803f80
v_mfma_f32_16x16x32_bf16 v[120:123], v[104:107], v[72:75], v[120:123]
ds_read_b64_tr_b16 v[62:63], v16 offset:8704
s_mov_b32 s59, 0x0
v_mfma_f32_16x16x32_bf16 v[152:155], v[108:111], v[72:75], v[152:155]
ds_read_b64_tr_b16 v[64:65], v16 offset:16384
v_add_u32 v248, 2, v247
v_mfma_f32_16x16x32_bf16 v[188:191], v[72:75], v[112:115], v[188:191]
ds_read_b64_tr_b16 v[66:67], v16 offset:16896
v_sub_u32 v249, v248, v246
v_mfma_f32_16x16x32_bf16 v[124:127], v[104:107], v[76:79], v[124:127]
ds_read_b128 v[20:23], v15 offset:0
v_sub_u32 v250, v246, v248
v_mfma_f32_16x16x32_bf16 v[156:159], v[108:111], v[76:79], v[156:159]
ds_read_b128 v[24:27], v15 offset:2048
buffer_load_dwordx4 v240, s[40:43], s59 offen lds
v_mfma_f32_16x16x32_bf16 v[192:195], v[76:79], v[112:115], v[192:195]
ds_read_b128 v[28:31], v15 offset:4096
v_mfma_f32_16x16x32_bf16 v[128:131], v[104:107], v[80:83], v[128:131]
ds_read_b128 v[32:35], v15 offset:6144
v_mfma_f32_16x16x32_bf16 v[160:163], v[108:111], v[80:83], v[160:163]
ds_read_b128 v[36:39], v15 offset:8192
v_mfma_f32_16x16x32_bf16 v[196:199], v[80:83], v[112:115], v[196:199]
ds_read_b128 v[40:43], v15 offset:10240
buffer_load_dwordx4 v241, s[40:43], s59 offen offset:1024 lds
v_mfma_f32_16x16x32_bf16 v[132:135], v[104:107], v[84:87], v[132:135]
ds_read_b128 v[44:47], v15 offset:12288
v_add_u32 v13, s65, v11
v_mfma_f32_16x16x32_bf16 v[164:167], v[108:111], v[84:87], v[164:167]
ds_read_b128 v[48:51], v15 offset:14336
v_mov_b32 v14, v16
v_mfma_f32_16x16x32_bf16 v[200:203], v[84:87], v[112:115], v[200:203]
ds_read_b128 v[52:55], v15 offset:16384
v_mfma_f32_16x16x32_bf16 v[136:139], v[104:107], v[88:91], v[136:139]
buffer_load_dwordx4 v242, s[40:43], s59 offen offset:2048 lds
s_mov_b32 s53, s64
v_mfma_f32_16x16x32_bf16 v[168:171], v[108:111], v[88:91], v[168:171]
v_cmp_le_i32 vcc, 9, v249
s_nop 1
v_cndmask_b32_e64 v222, v251, 0, vcc
v_mfma_f32_16x16x32_bf16 v[204:207], v[88:91], v[112:115], v[204:207]
v_cmp_ge_u32 vcc, 7, v250
s_nop 1
v_cndmask_b32_e64 v226, v251, 0, vcc
v_mfma_f32_16x16x32_bf16 v[140:143], v[104:107], v[92:95], v[140:143]
v_cmp_le_i32 vcc, 1, v249
v_cmp_ge_u32 s[54:55], 7, v248
v_mfma_f32_16x16x32_bf16 v[172:175], v[108:111], v[92:95], v[172:175]
buffer_load_dwordx4 v243, s[40:43], s59 offen offset:3072 lds
s_nop 1
s_and_b64 vcc, vcc, s[54:55]
v_mfma_f32_16x16x32_bf16 v[208:211], v[92:95], v[112:115], v[208:211]
v_cndmask_b32_e64 v230, v251, 0, vcc
v_min_f32 v230, s63, v230
v_mfma_f32_16x16x32_bf16 v[144:147], v[104:107], v[96:99], v[144:147]
v_min_f32 v234, s63, v222
v_mov_b32 v238, 0x3f803f80
v_mfma_f32_16x16x32_bf16 v[176:179], v[108:111], v[96:99], v[176:179]
v_add_u32 v248, 3, v247
v_sub_u32 v249, v248, v246
v_mfma_f32_16x16x32_bf16 v[212:215], v[96:99], v[112:115], v[212:215]
v_sub_u32 v250, v246, v248
s_mov_b32 s64, s65
v_mfma_f32_16x16x32_bf16 v[180:183], v[108:111], v[100:103], v[180:183]
v_cmp_le_i32 vcc, 9, v249
s_nop 1
v_cndmask_b32_e64 v223, v251, 0, vcc
v_mfma_f32_16x16x32_bf16 v[216:219], v[100:103], v[112:115], v[216:219]
v_cmp_ge_u32 vcc, 7, v250
s_nop 1
v_cndmask_b32_e64 v227, v251, 0, vcc
v_cmp_le_i32 vcc, 1, v249
v_cmp_ge_u32 s[54:55], 7, v248
s_nop 3
s_and_b64 vcc, vcc, s[54:55]
v_cndmask_b32_e64 v231, v251, 0, vcc
v_min_f32 v231, s63, v231
v_min_f32 v235, s63, v223
v_mov_b32 v239, 0x3f803f80
s_mov_b32 s65, s66
s_mov_b32 s66, s53
s_waitcnt lgkmcnt(0)
v_mfma_f32_16x16x32_bf16 v[116:119], v[56:59], v[20:23], v[116:119]
ds_read_b64_tr_b16 v[104:105], v14 offset:4096
s_add_u32 m0, s70, 0x1000
v_mfma_f32_16x16x32_bf16 v[148:151], v[60:63], v[20:23], v[148:151]
ds_read_b64_tr_b16 v[106:107], v14 offset:4608
v_mfma_f32_16x16x32_bf16 v[184:187], v[20:23], v[64:67], v[184:187]
ds_read_b64_tr_b16 v[108:109], v14 offset:12288
v_mfma_f32_16x16x32_bf16 v[120:123], v[56:59], v[24:27], v[120:123]
ds_read_b64_tr_b16 v[110:111], v14 offset:12800
s_mov_b32 s59, 0x8000
v_mfma_f32_16x16x32_bf16 v[152:155], v[60:63], v[24:27], v[152:155]
ds_read_b64_tr_b16 v[112:113], v14 offset:20480
v_mfma_f32_16x16x32_bf16 v[188:191], v[24:27], v[64:67], v[188:191]
ds_read_b64_tr_b16 v[114:115], v14 offset:20992
v_mfma_f32_16x16x32_bf16 v[124:127], v[56:59], v[28:31], v[124:127]
ds_read_b128 v[68:71], v13 offset:0
v_mfma_f32_16x16x32_bf16 v[156:159], v[60:63], v[28:31], v[156:159]
ds_read_b128 v[72:75], v13 offset:2048
buffer_load_dwordx4 v240, s[40:43], s59 offen lds
v_mfma_f32_16x16x32_bf16 v[192:195], v[28:31], v[64:67], v[192:195]
ds_read_b128 v[76:79], v13 offset:4096
v_mfma_f32_16x16x32_bf16 v[128:131], v[56:59], v[32:35], v[128:131]
ds_read_b128 v[80:83], v13 offset:6144
v_mfma_f32_16x16x32_bf16 v[160:163], v[60:63], v[32:35], v[160:163]
ds_read_b128 v[84:87], v13 offset:8192
v_mfma_f32_16x16x32_bf16 v[196:199], v[32:35], v[64:67], v[196:199]
ds_read_b128 v[88:91], v13 offset:10240
buffer_load_dwordx4 v241, s[40:43], s59 offen offset:1024 lds
v_mfma_f32_16x16x32_bf16 v[132:135], v[56:59], v[36:39], v[132:135]
ds_read_b128 v[92:95], v13 offset:12288
v_mfma_f32_16x16x32_bf16 v[164:167], v[60:63], v[36:39], v[164:167]
ds_read_b128 v[96:99], v13 offset:14336
v_mfma_f32_16x16x32_bf16 v[200:203], v[36:39], v[64:67], v[200:203]
ds_read_b128 v[100:103], v13 offset:16384
v_mfma_f32_16x16x32_bf16 v[136:139], v[56:59], v[40:43], v[136:139]
buffer_load_dwordx4 v242, s[40:43], s59 offen offset:2048 lds
v_mfma_f32_16x16x32_bf16 v[168:171], v[60:63], v[40:43], v[168:171]
v_mfma_f32_16x16x32_bf16 v[204:207], v[40:43], v[64:67], v[204:207]
v_mfma_f32_16x16x32_bf16 v[140:143], v[56:59], v[44:47], v[140:143]
v_mfma_f32_16x16x32_bf16 v[172:175], v[60:63], v[44:47], v[172:175]
buffer_load_dwordx4 v243, s[40:43], s59 offen offset:3072 lds
v_mfma_f32_16x16x32_bf16 v[208:211], v[44:47], v[64:67], v[208:211]
v_mfma_f32_16x16x32_bf16 v[144:147], v[56:59], v[48:51], v[144:147]
v_mfma_f32_16x16x32_bf16 v[176:179], v[60:63], v[48:51], v[176:179]
v_mfma_f32_16x16x32_bf16 v[212:215], v[48:51], v[64:67], v[212:215]
v_mfma_f32_16x16x32_bf16 v[180:183], v[60:63], v[52:55], v[180:183]
v_mfma_f32_16x16x32_bf16 v[216:219], v[52:55], v[64:67], v[216:219]
s_waitcnt lgkmcnt(0)
s_barrier
v_mfma_f32_16x16x32_bf16 v[116:119], v[104:107], v[68:71], v[116:119]
s_add_u32 m0, s70, 0x2000
v_mfma_f32_16x16x32_bf16 v[148:151], v[108:111], v[68:71], v[148:151]
v_mfma_f32_16x16x32_bf16 v[184:187], v[68:71], v[112:115], v[184:187]
v_mfma_f32_16x16x32_bf16 v[120:123], v[104:107], v[72:75], v[120:123]
s_mov_b32 s59, 0x10000
v_mfma_f32_16x16x32_bf16 v[152:155], v[108:111], v[72:75], v[152:155]
v_mfma_f32_16x16x32_bf16 v[188:191], v[72:75], v[112:115], v[188:191]
v_mfma_f32_16x16x32_bf16 v[124:127], v[104:107], v[76:79], v[124:127]
v_mfma_f32_16x16x32_bf16 v[156:159], v[108:111], v[76:79], v[156:159]
buffer_load_dwordx4 v240, s[40:43], s59 offen lds
v_mfma_f32_16x16x32_bf16 v[192:195], v[76:79], v[112:115], v[192:195]
v_mfma_f32_16x16x32_bf16 v[128:131], v[104:107], v[80:83], v[128:131]
v_mfma_f32_16x16x32_bf16 v[160:163], v[108:111], v[80:83], v[160:163]
v_mfma_f32_16x16x32_bf16 v[196:199], v[80:83], v[112:115], v[196:199]
buffer_load_dwordx4 v241, s[40:43], s59 offen offset:1024 lds
v_mfma_f32_16x16x32_bf16 v[132:135], v[104:107], v[84:87], v[132:135]
v_mfma_f32_16x16x32_bf16 v[164:167], v[108:111], v[84:87], v[164:167]
v_mfma_f32_16x16x32_bf16 v[200:203], v[84:87], v[112:115], v[200:203]
v_mfma_f32_16x16x32_bf16 v[136:139], v[104:107], v[88:91], v[136:139]
buffer_load_dwordx4 v242, s[40:43], s59 offen offset:2048 lds
v_mfma_f32_16x16x32_bf16 v[168:171], v[108:111], v[88:91], v[168:171]
v_mfma_f32_16x16x32_bf16 v[204:207], v[88:91], v[112:115], v[204:207]
v_mfma_f32_16x16x32_bf16 v[140:143], v[104:107], v[92:95], v[140:143]
v_mfma_f32_16x16x32_bf16 v[172:175], v[108:111], v[92:95], v[172:175]
buffer_load_dwordx4 v243, s[40:43], s59 offen offset:3072 lds
v_mfma_f32_16x16x32_bf16 v[208:211], v[92:95], v[112:115], v[208:211]
v_mfma_f32_16x16x32_bf16 v[144:147], v[104:107], v[96:99], v[144:147]
v_mfma_f32_16x16x32_bf16 v[176:179], v[108:111], v[96:99], v[176:179]
v_mfma_f32_16x16x32_bf16 v[212:215], v[96:99], v[112:115], v[212:215]
v_mfma_f32_16x16x32_bf16 v[180:183], v[108:111], v[100:103], v[180:183]
v_mfma_f32_16x16x32_bf16 v[216:219], v[100:103], v[112:115], v[216:219]
v_cvt_pk_bf16_f32 v20, v116, v117
v_mov_b32 v244, 0
global_load_dword v245, v244, s[22:23] sc1
v_cvt_pk_bf16_f32 v21, v118, v119
v_cvt_pk_bf16_f32 v22, v120, v121
v_cvt_pk_bf16_f32 v23, v122, v123
v_cvt_pk_bf16_f32 v24, v124, v125
v_cvt_pk_bf16_f32 v25, v126, v127
v_cvt_pk_bf16_f32 v26, v128, v129
v_cvt_pk_bf16_f32 v27, v130, v131
v_cvt_pk_bf16_f32 v28, v132, v133
s_add_u32 m0, s70, 0x3000
s_mov_b32 s59, 0x18000
buffer_load_dwordx4 v240, s[40:43], s59 offen lds
v_cvt_pk_bf16_f32 v29, v134, v135
v_cvt_pk_bf16_f32 v30, v136, v137
v_cvt_pk_bf16_f32 v31, v138, v139
v_cvt_pk_bf16_f32 v32, v140, v141
v_cvt_pk_bf16_f32 v33, v142, v143
v_cvt_pk_bf16_f32 v34, v144, v145
v_cvt_pk_bf16_f32 v35, v146, v147
v_cvt_pk_bf16_f32 v36, v148, v149
v_cvt_pk_bf16_f32 v37, v150, v151
v_cvt_pk_bf16_f32 v38, v152, v153
buffer_load_dwordx4 v241, s[40:43], s59 offen offset:1024 lds
v_cvt_pk_bf16_f32 v39, v154, v155
v_cvt_pk_bf16_f32 v40, v156, v157
v_cvt_pk_bf16_f32 v41, v158, v159
v_cvt_pk_bf16_f32 v42, v160, v161
v_cvt_pk_bf16_f32 v43, v162, v163
v_cvt_pk_bf16_f32 v44, v164, v165
v_cvt_pk_bf16_f32 v45, v166, v167
v_cvt_pk_bf16_f32 v46, v168, v169
v_cvt_pk_bf16_f32 v47, v170, v171
v_cvt_pk_bf16_f32 v48, v172, v173
buffer_load_dwordx4 v242, s[40:43], s59 offen offset:2048 lds
v_cvt_pk_bf16_f32 v49, v174, v175
v_cvt_pk_bf16_f32 v50, v176, v177
v_cvt_pk_bf16_f32 v51, v178, v179
v_cvt_pk_bf16_f32 v52, v180, v181
v_cvt_pk_bf16_f32 v53, v182, v183
v_cvt_pk_bf16_f32 v54, v216, v217
v_cvt_pk_bf16_f32 v55, v218, v219
v_cvt_pk_bf16_f32 v56, v184, v185
v_cvt_pk_bf16_f32 v57, v186, v187
v_cvt_pk_bf16_f32 v58, v188, v189
buffer_load_dwordx4 v243, s[40:43], s59 offen offset:3072 lds
v_cvt_pk_bf16_f32 v59, v190, v191
v_cvt_pk_bf16_f32 v60, v192, v193
v_cvt_pk_bf16_f32 v61, v194, v195
v_cvt_pk_bf16_f32 v62, v196, v197
v_cvt_pk_bf16_f32 v63, v198, v199
v_cvt_pk_bf16_f32 v64, v216, v217
v_cvt_pk_bf16_f32 v65, v218, v219
v_cvt_pk_bf16_f32 v66, v200, v201
v_cvt_pk_bf16_f32 v67, v202, v203
v_cvt_pk_bf16_f32 v68, v204, v205
v_cvt_pk_bf16_f32 v69, v206, v207
v_cvt_pk_bf16_f32 v70, v208, v209
v_cvt_pk_bf16_f32 v71, v210, v211
v_cvt_pk_bf16_f32 v72, v212, v213
v_cvt_pk_bf16_f32 v73, v214, v215
v_mov_b32_dpp v106, v52 row_ror:8 row_mask:0xf bank_mask:0xf
v_mov_b32_dpp v107, v53 row_ror:8 row_mask:0xf bank_mask:0xf
v_mov_b32 v108, v54
v_mov_b32 v109, v55
s_nop 0
v_permlane32_swap_b32 v54, v108
v_permlane32_swap_b32 v55, v109
v_mfma_f32_16x16x16_bf16 v[116:119], v[106:107], v[20:21], v[232:235]
v_mov_b32 v74, 0
v_mov_b32 v75, 0
v_mfma_f32_16x16x16_bf16 v[120:123], v[36:37], v[20:21], v[224:227]
v_mov_b32 v76, 0
v_mov_b32 v77, 0
v_mfma_f32_16x16x16_bf16 v[124:127], v[36:37], v[22:23], v[220:223]
v_mov_b32 v78, 0
v_mov_b32 v79, 0
v_mfma_f32_16x16x16_bf16 v[128:131], v[38:39], v[22:23], v[224:227]
v_mov_b32 v80, 0
v_mov_b32 v81, 0
v_mfma_f32_16x16x16_bf16 v[132:135], v[38:39], v[24:25], v[220:223]
v_mov_b32 v82, 0
v_mov_b32 v83, 0
v_mfma_f32_16x16x16_bf16 v[136:139], v[40:41], v[24:25], v[224:227]
v_mov_b32 v84, 0
v_mov_b32 v85, 0
v_max_f32 v116, v116, v120
v_max_f32 v117, v117, v121
v_max_f32 v118, v118, v122
v_mfma_f32_16x16x16_bf16 v[140:143], v[40:41], v[26:27], v[220:223]
v_max_f32 v119, v119, v123
v_max3_f32 v180, v116, v117, v118
v_max_f32 v180, v180, v119
v_mfma_f32_16x16x16_bf16 v[144:147], v[42:43], v[26:27], v[224:227]
v_max_f32 v124, v124, v128
v_max_f32 v125, v125, v129
v_max_f32 v126, v126, v130
v_mfma_f32_16x16x16_bf16 v[148:151], v[52:53], v[28:29], v[232:235]
v_max_f32 v127, v127, v131
v_max3_f32 v181, v124, v125, v126
v_max_f32 v181, v181, v127
v_mfma_f32_16x16x16_bf16 v[152:155], v[44:45], v[28:29], v[224:227]
v_max_f32 v132, v132, v136
v_max_f32 v133, v133, v137
v_max_f32 v134, v134, v138
v_mfma_f32_16x16x16_bf16 v[156:159], v[44:45], v[30:31], v[220:223]
v_max_f32 v135, v135, v139
v_max3_f32 v182, v132, v133, v134
v_max_f32 v182, v182, v135
v_mfma_f32_16x16x16_bf16 v[160:163], v[46:47], v[30:31], v[224:227]
v_max_f32 v140, v140, v144
v_max_f32 v141, v141, v145
v_max_f32 v142, v142, v146
v_mfma_f32_16x16x16_bf16 v[164:167], v[46:47], v[32:33], v[220:223]
v_max_f32 v143, v143, v147
v_max3_f32 v183, v140, v141, v142
v_max_f32 v183, v183, v143
v_mfma_f32_16x16x16_bf16 v[168:171], v[48:49], v[32:33], v[224:227]
v_max_f32 v148, v148, v152
v_max_f32 v149, v149, v153
v_max_f32 v150, v150, v154
v_mfma_f32_16x16x16_bf16 v[172:175], v[48:49], v[34:35], v[220:223]
v_max_f32 v151, v151, v155
v_max3_f32 v184, v148, v149, v150
v_max_f32 v184, v184, v151
v_mfma_f32_16x16x16_bf16 v[176:179], v[50:51], v[34:35], v[224:227]
v_max_f32 v156, v156, v160
v_max_f32 v157, v157, v161
v_max_f32 v158, v158, v162
v_max_f32 v159, v159, v163
v_max3_f32 v185, v156, v157, v158
v_max_f32 v185, v185, v159
v_max_f32 v164, v164, v168
v_max_f32 v165, v165, v169
v_max_f32 v166, v166, v170
v_max_f32 v167, v167, v171
v_max3_f32 v186, v164, v165, v166
v_max_f32 v186, v186, v167
v_max_f32 v172, v172, v176
v_max_f32 v173, v173, v177
v_max_f32 v174, v174, v178
v_max_f32 v175, v175, v179
v_max3_f32 v187, v172, v173, v174
v_max_f32 v187, v187, v175
v_mov_b32 v86, 0
v_mov_b32 v87, 0
v_mov_b32 v88, 0
v_mov_b32 v89, 0
v_mov_b32 v90, 0
v_mov_b32 v91, 0
v_mov_b32 v92, 0
v_mov_b32 v93, 0
v_mov_b32 v94, 0
v_mov_b32 v95, 0
v_mov_b32 v96, 0
v_mov_b32 v97, 0
v_mov_b32 v98, 0
v_mov_b32 v99, 0
v_mov_b32 v100, 0
v_mov_b32 v101, 0
v_mov_b32 v102, 0
v_mov_b32 v103, 0
v_mov_b32 v104, 0
v_mov_b32 v105, 0
s_mov_b32 s52, 0x3eb8aa3b
s_mov_b32 s53, s52
v_permlane16_swap_b32 v180, v181
v_permlane16_swap_b32 v184, v185
v_permlane16_swap_b32 v182, v183
v_permlane16_swap_b32 v186, v187
v_max_f32 v180, v180, v181
v_max_f32 v184, v184, v185
v_max_f32 v182, v182, v183
v_max_f32 v186, v186, v187
s_nop 0
v_permlane32_swap_b32 v180, v182
v_permlane32_swap_b32 v184, v186
v_max_f32 v180, v180, v182
v_max_f32 v184, v184, v186
v_mul_f32 v180, s52, v180
v_mul_f32 v184, s52, v184
v_mov_b32 v182, v180
v_mov_b32 v186, v184
s_nop 0
v_permlane32_swap_b32 v180, v182
v_permlane32_swap_b32 v184, v186
v_mov_b32 v181, v180
v_mov_b32 v185, v184
v_mov_b32 v183, v182
v_mov_b32 v187, v186
v_permlane16_swap_b32 v180, v181
v_permlane16_swap_b32 v184, v185
v_permlane16_swap_b32 v182, v183
v_permlane16_swap_b32 v186, v187
v_pk_fma_f32 v[116:117], v[116:117], s[52:53], v[180:181] op_sel:[0,0,0] op_sel_hi:[1,1,0] neg_lo:[0,0,1] neg_hi:[0,0,1]
v_pk_fma_f32 v[118:119], v[118:119], s[52:53], v[180:181] op_sel:[0,0,0] op_sel_hi:[1,1,0] neg_lo:[0,0,1] neg_hi:[0,0,1]
v_exp_f32 v116, v116
v_exp_f32 v117, v117
v_exp_f32 v118, v118
v_exp_f32 v119, v119
v_pk_fma_f32 v[124:125], v[124:125], s[52:53], v[180:181] op_sel:[0,0,1] op_sel_hi:[1,1,1] neg_lo:[0,0,1] neg_hi:[0,0,1]
v_pk_fma_f32 v[126:127], v[126:127], s[52:53], v[180:181] op_sel:[0,0,1] op_sel_hi:[1,1,1] neg_lo:[0,0,1] neg_hi:[0,0,1]
v_exp_f32 v124, v124
v_exp_f32 v125, v125
v_exp_f32 v126, v126
v_exp_f32 v127, v127
v_pk_fma_f32 v[132:133], v[132:133], s[52:53], v[182:183] op_sel:[0,0,0] op_sel_hi:[1,1,0] neg_lo:[0,0,1] neg_hi:[0,0,1]
v_pk_fma_f32 v[134:135], v[134:135], s[52:53], v[182:183] op_sel:[0,0,0] op_sel_hi:[1,1,0] neg_lo:[0,0,1] neg_hi:[0,0,1]
v_exp_f32 v132, v132
v_exp_f32 v133, v133
v_exp_f32 v134, v134
v_exp_f32 v135, v135
v_pk_fma_f32 v[140:141], v[140:141], s[52:53], v[182:183] op_sel:[0,0,1] op_sel_hi:[1,1,1] neg_lo:[0,0,1] neg_hi:[0,0,1]
v_pk_fma_f32 v[142:143], v[142:143], s[52:53], v[182:183] op_sel:[0,0,1] op_sel_hi:[1,1,1] neg_lo:[0,0,1] neg_hi:[0,0,1]
v_exp_f32 v140, v140
v_exp_f32 v141, v141
v_exp_f32 v142, v142
v_exp_f32 v143, v143
v_pk_fma_f32 v[148:149], v[148:149], s[52:53], v[184:185] op_sel:[0,0,0] op_sel_hi:[1,1,0] neg_lo:[0,0,1] neg_hi:[0,0,1]
v_pk_fma_f32 v[150:151], v[150:151], s[52:53], v[184:185] op_sel:[0,0,0] op_sel_hi:[1,1,0] neg_lo:[0,0,1] neg_hi:[0,0,1]
v_exp_f32 v148, v148
v_exp_f32 v149, v149
v_exp_f32 v150, v150
v_exp_f32 v151, v151
v_pk_fma_f32 v[156:157], v[156:157], s[52:53], v[184:185] op_sel:[0,0,1] op_sel_hi:[1,1,1] neg_lo:[0,0,1] neg_hi:[0,0,1]
v_pk_fma_f32 v[158:159], v[158:159], s[52:53], v[184:185] op_sel:[0,0,1] op_sel_hi:[1,1,1] neg_lo:[0,0,1] neg_hi:[0,0,1]
v_exp_f32 v156, v156
v_exp_f32 v157, v157
v_exp_f32 v158, v158
v_exp_f32 v159, v159
v_pk_fma_f32 v[164:165], v[164:165], s[52:53], v[186:187] op_sel:[0,0,0] op_sel_hi:[1,1,0] neg_lo:[0,0,1] neg_hi:[0,0,1]
v_pk_fma_f32 v[166:167], v[166:167], s[52:53], v[186:187] op_sel:[0,0,0] op_sel_hi:[1,1,0] neg_lo:[0,0,1] neg_hi:[0,0,1]
v_exp_f32 v164, v164
v_exp_f32 v165, v165
v_exp_f32 v166, v166
v_exp_f32 v167, v167
v_pk_fma_f32 v[172:173], v[172:173], s[52:53], v[186:187] op_sel:[0,0,1] op_sel_hi:[1,1,1] neg_lo:[0,0,1] neg_hi:[0,0,1]
v_pk_fma_f32 v[174:175], v[174:175], s[52:53], v[186:187] op_sel:[0,0,1] op_sel_hi:[1,1,1] neg_lo:[0,0,1] neg_hi:[0,0,1]
v_exp_f32 v172, v172
v_exp_f32 v173, v173
v_exp_f32 v174, v174
v_exp_f32 v175, v175
s_mov_b32 exec_lo, 0
s_mov_b32 exec_hi, 0x00ff00ff
v_cvt_pk_bf16_f32 v74, v116, v117
v_cvt_pk_bf16_f32 v75, v118, v119
v_cvt_pk_bf16_f32 v78, v124, v125
v_cvt_pk_bf16_f32 v79, v126, v127
v_cvt_pk_bf16_f32 v82, v132, v133
v_cvt_pk_bf16_f32 v83, v134, v135
v_cvt_pk_bf16_f32 v86, v140, v141
v_cvt_pk_bf16_f32 v87, v142, v143
v_cvt_pk_bf16_f32 v90, v148, v149
v_cvt_pk_bf16_f32 v91, v150, v151
v_cvt_pk_bf16_f32 v94, v156, v157
v_cvt_pk_bf16_f32 v95, v158, v159
v_cvt_pk_bf16_f32 v98, v164, v165
v_cvt_pk_bf16_f32 v99, v166, v167
v_cvt_pk_bf16_f32 v102, v172, v173
v_cvt_pk_bf16_f32 v103, v174, v175
s_not_b64 exec, exec
v_cvt_pk_bf16_f32 v76, v116, v117
v_cvt_pk_bf16_f32 v77, v118, v119
v_cvt_pk_bf16_f32 v80, v124, v125
v_cvt_pk_bf16_f32 v81, v126, v127
v_cvt_pk_bf16_f32 v84, v132, v133
v_cvt_pk_bf16_f32 v85, v134, v135
v_cvt_pk_bf16_f32 v88, v140, v141
v_cvt_pk_bf16_f32 v89, v142, v143
v_cvt_pk_bf16_f32 v92, v148, v149
v_cvt_pk_bf16_f32 v93, v150, v151
v_cvt_pk_bf16_f32 v96, v156, v157
v_cvt_pk_bf16_f32 v97, v158, v159
v_cvt_pk_bf16_f32 v100, v164, v165
v_cvt_pk_bf16_f32 v101, v166, v167
v_cvt_pk_bf16_f32 v104, v172, v173
v_cvt_pk_bf16_f32 v105, v174, v175
s_mov_b64 exec, -1
v_mfma_f32_16x16x32_bf16 v[116:119], v[54:57], v[74:77], 0
s_lshl_b32 s52, s28, 2
s_add_u32 s52, s52, s29
v_mfma_f32_16x16x32_bf16 v[120:123], v[236:239], v[74:77], 0
s_lshl_b32 s52, s52, 10
v_lshlrev_b32 v16, 4, v1
v_mfma_f32_16x16x32_bf16 v[124:127], v[56:59], v[78:81], 0
v_add_u32 v16, s52, v16
s_add_u32 s53, s27, 16
v_mfma_f32_16x16x32_bf16 v[128:131], v[236:239], v[78:81], 0
s_lshl_b32 s53, s53, 17
s_add_u32 s53, s53, 0x100000
v_mfma_f32_16x16x32_bf16 v[132:135], v[58:61], v[82:85], 0
v_mfma_f32_16x16x32_bf16 v[136:139], v[236:239], v[82:85], 0
v_mfma_f32_16x16x32_bf16 v[140:143], v[60:63], v[86:89], 0
v_rcp_f32 v120, v120
s_nop 1
v_rcp_f32 v128, v128
v_mfma_f32_16x16x32_bf16 v[144:147], v[236:239], v[86:89], 0
v_pk_mul_f32 v[116:117], v[116:117], v[120:121] op_sel_hi:[1,0]
v_pk_mul_f32 v[118:119], v[118:119], v[120:121] op_sel_hi:[1,0]
v_mfma_f32_16x16x32_bf16 v[148:151], v[64:67], v[90:93], 0
v_pk_mul_f32 v[124:125], v[124:125], v[128:129] op_sel_hi:[1,0]
v_pk_mul_f32 v[126:127], v[126:127], v[128:129] op_sel_hi:[1,0]
v_mfma_f32_16x16x32_bf16 v[152:155], v[236:239], v[90:93], 0
v_cvt_pk_bf16_f32 v20, v116, v117
v_cvt_pk_bf16_f32 v21, v118, v119
v_mfma_f32_16x16x32_bf16 v[156:159], v[66:69], v[94:97], 0
v_cvt_pk_bf16_f32 v22, v124, v125
v_cvt_pk_bf16_f32 v23, v126, v127
v_mfma_f32_16x16x32_bf16 v[160:163], v[236:239], v[94:97], 0
v_permlane16_swap_b32 v20, v22
v_permlane16_swap_b32 v21, v23
v_mfma_f32_16x16x32_bf16 v[164:167], v[68:71], v[98:101], 0
s_add_u32 s54, s53, 0x0
buffer_store_dwordx4 v[20:23], v16, s[44:47], s54 offen sc1
v_rcp_f32 v136, v136
v_rcp_f32 v144, v144
v_mfma_f32_16x16x32_bf16 v[168:171], v[236:239], v[98:101], 0
v_pk_mul_f32 v[132:133], v[132:133], v[136:137] op_sel_hi:[1,0]
v_pk_mul_f32 v[134:135], v[134:135], v[136:137] op_sel_hi:[1,0]
v_mfma_f32_16x16x32_bf16 v[172:175], v[70:73], v[102:105], 0
v_pk_mul_f32 v[140:141], v[140:141], v[144:145] op_sel_hi:[1,0]
v_pk_mul_f32 v[142:143], v[142:143], v[144:145] op_sel_hi:[1,0]
v_mfma_f32_16x16x32_bf16 v[176:179], v[236:239], v[102:105], 0
v_cvt_pk_bf16_f32 v24, v132, v133
v_cvt_pk_bf16_f32 v25, v134, v135
v_cvt_pk_bf16_f32 v26, v140, v141
v_cvt_pk_bf16_f32 v27, v142, v143
s_nop 0
v_permlane16_swap_b32 v24, v26
v_permlane16_swap_b32 v25, v27
s_add_u32 s54, s53, 0x8000
buffer_store_dwordx4 v[24:27], v16, s[44:47], s54 offen sc1
v_rcp_f32 v152, v152
v_rcp_f32 v160, v160
v_pk_mul_f32 v[148:149], v[148:149], v[152:153] op_sel_hi:[1,0]
v_pk_mul_f32 v[150:151], v[150:151], v[152:153] op_sel_hi:[1,0]
v_pk_mul_f32 v[156:157], v[156:157], v[160:161] op_sel_hi:[1,0]
v_pk_mul_f32 v[158:159], v[158:159], v[160:161] op_sel_hi:[1,0]
v_cvt_pk_bf16_f32 v28, v148, v149
v_cvt_pk_bf16_f32 v29, v150, v151
v_cvt_pk_bf16_f32 v30, v156, v157
v_cvt_pk_bf16_f32 v31, v158, v159
s_nop 0
v_permlane16_swap_b32 v28, v30
v_permlane16_swap_b32 v29, v31
s_add_u32 s54, s53, 0x10000
buffer_store_dwordx4 v[28:31], v16, s[44:47], s54 offen sc1
v_rcp_f32 v168, v168
v_rcp_f32 v176, v176
v_pk_mul_f32 v[164:165], v[164:165], v[168:169] op_sel_hi:[1,0]
v_pk_mul_f32 v[166:167], v[166:167], v[168:169] op_sel_hi:[1,0]
v_pk_mul_f32 v[172:173], v[172:173], v[176:177] op_sel_hi:[1,0]
v_pk_mul_f32 v[174:175], v[174:175], v[176:177] op_sel_hi:[1,0]
v_cvt_pk_bf16_f32 v32, v164, v165
v_cvt_pk_bf16_f32 v33, v166, v167
v_cvt_pk_bf16_f32 v34, v172, v173
v_cvt_pk_bf16_f32 v35, v174, v175
s_nop 0
v_permlane16_swap_b32 v32, v34
v_permlane16_swap_b32 v33, v35
s_add_u32 s54, s53, 0x18000
buffer_store_dwordx4 v[32:35], v16, s[44:47], s54 offen sc1
s_waitcnt vmcnt(8)
v_readfirstlane_b32 s57, v245
s_nop 3
s_cmp_ge_u32 s57, 16
s_cbranch_scc1 L_ok_initB
s_mov_b32 s56, 0
L_spin_initB:
global_load_dword v245, v244, s[22:23] sc1
s_waitcnt vmcnt(0)
v_readfirstlane_b32 s57, v245
s_add_u32 s56, s56, 1
s_cmp_ge_u32 s56, 0xf4240
s_cbranch_scc1 L_spun_initB
s_nop 0
s_cmp_lt_u32 s57, 16
s_cbranch_scc1 L_spin_initB
L_spun_initB:
L_ok_initB:
s_lshl_b32 s52, s30, 7
s_and_b32 s53, s29, 1
s_lshl_b32 s53, s53, 6
s_lshr_b32 s54, s29, 1
s_add_u32 s52, s52, s53
s_add_u32 s52, s52, s54
s_lshl_b32 s74, s52, 11
s_add_u32 s74, s74, 1024
s_mov_b32 s75, 12
s_waitcnt vmcnt(0)
s_barrier
s_cmp_eq_u32 s29, 0
s_cbranch_scc0 L_nosig8_1
s_lshl_b32 s59, s27, 8
s_add_u32 s59, s59, 0x2000
v_mov_b32 v8, s59
v_mov_b32 v9, 1
s_mov_b64 exec, 1
global_atomic_add v8, v9, s[24:25] sc1
s_mov_b64 exec, -1
L_nosig8_1:
L_P2:
s_mov_b32 s48, s20
s_mov_b32 s49, s21
s_mov_b32 s50, 0x400000
s_mov_b32 s51, 0x20000
s_lshl_b32 s52, s26, 4
s_add_u32 s52, s52, s30
s_lshl_b32 s52, s52, 2
s_add_u32 s52, s52, s29
s_lshl_b32 s52, s52, 15
s_add_u32 s52, s52, 0x100000
v_lshlrev_b32 v2, 4, v1
v_lshrrev_b32 v3, 5, v1
v_lshlrev_b32 v3, 10, v3
v_bfe_u32 v4, v1, 2, 2
v_lshl_add_u32 v3, v4, 7, v3
v_bfe_u32 v4, v1, 4, 1
v_lshl_add_u32 v3, v4, 5, v3
v_and_b32 v4, 3, v1
v_lshl_add_u32 v3, v4, 3, v3
v_bfe_u32 v4, v1, 3, 1
v_lshlrev_b32 v4, 6, v4
v_xor_b32 v3, v3, v4
v_add_u32 v3, 98304, v3
v_xor_b32 v4, 64, v3
s_cmp_eq_u32 s29, 0
s_cbranch_scc0 L_nosig8
s_lshl_b32 s58, s26, 4
s_add_u32 s58, s58, s30
s_lshl_b32 s58, s58, 8
s_add_u32 s58, s58, 0x1000
v_mov_b32 v12, s58
global_load_dword v13, v12, s[24:25] sc1
L_nosig8:
s_mov_b32 s60, s52
s_mov_b32 s61, s28
s_lshl_b32 s62, s28, 13
v_add_u32 v5, s62, v3
v_xor_b32 v6, 64, v5
s_lshl_b32 s52, s61, 12
s_add_u32 s52, s52, s60
s_add_u32 s61, s61, 1
s_and_b32 s61, s61, 7
buffer_load_dwordx4 a[0:3], v2, s[44:47], s52 offen offset:0 sc1
buffer_load_dwordx4 a[4:7], v2, s[44:47], s52 offen offset:1024 sc1
buffer_load_dwordx4 a[8:11], v2, s[44:47], s52 offen offset:2048 sc1
buffer_load_dwordx4 a[12:15], v2, s[44:47], s52 offen offset:3072 sc1
ds_read_b64_tr_b16 v[20:21], v5 offset:0
ds_read_b64_tr_b16 v[22:23], v5 offset:512
ds_read_b64_tr_b16 v[24:25], v6 offset:0
ds_read_b64_tr_b16 v[26:27], v6 offset:512
ds_read_b64_tr_b16 v[28:29], v5 offset:2048
ds_read_b64_tr_b16 v[30:31], v5 offset:2560
ds_read_b64_tr_b16 v[32:33], v6 offset:2048
ds_read_b64_tr_b16 v[34:35], v6 offset:2560
v_and_b32 v126, 31, v1
v_and_b32 v127, 7, v126
v_lshlrev_b32 v126, 7, v126
s_lshl_b32 s59, s29, 12
v_add_u32 v126, s59, v126
v_lshrrev_b32 v125, 5, v1
v_lshl_add_u32 v126, v125, 3, v126
v_xor_b32 v125, 0, v127
v_lshl_add_u32 v116, v125, 4, v126
v_xor_b32 v125, 1, v127
v_lshl_add_u32 v117, v125, 4, v126
v_xor_b32 v125, 2, v127
v_lshl_add_u32 v118, v125, 4, v126
v_xor_b32 v125, 3, v127
v_lshl_add_u32 v119, v125, 4, v126
v_xor_b32 v125, 4, v127
v_lshl_add_u32 v120, v125, 4, v126
v_xor_b32 v125, 5, v127
v_lshl_add_u32 v121, v125, 4, v126
v_xor_b32 v125, 6, v127
v_lshl_add_u32 v122, v125, 4, v126
v_xor_b32 v125, 7, v127
v_lshl_add_u32 v123, v125, 4, v126
v_lshrrev_b32 v126, 3, v1
v_and_b32 v127, 7, v1
v_xor_b32 v124, v126, v127
v_lshlrev_b32 v124, 4, v124
v_lshl_add_u32 v124, v126, 7, v124
v_add_u32 v124, s59, v124
v_lshlrev_b32 v125, s75, v126
v_lshl_add_u32 v125, v127, 4, v125
s_lshl_b32 s59, s31, 7
s_add_u32 s74, s74, s59
s_lshl_b32 s63, 8, s75
s_add_u32 s62, s62, 8192
s_and_b32 s62, s62, 0xffff
v_add_u32 v10, s62, v3
v_xor_b32 v11, 64, v10
ds_read_b64_tr_b16 v[36:37], v5 offset:4096
ds_read_b64_tr_b16 v[38:39], v5 offset:4608
ds_read_b64_tr_b16 v[40:41], v6 offset:4096
ds_read_b64_tr_b16 v[42:43], v6 offset:4608
s_waitcnt vmcnt(3) lgkmcnt(8)
v_mfma_f32_32x32x16_bf16 v[48:63], v[20:23], a[0:3], 0
v_mfma_f32_32x32x16_bf16 v[64:79], v[24:27], a[0:3], 0
ds_read_b64_tr_b16 v[20:21], v5 offset:6144
ds_read_b64_tr_b16 v[22:23], v5 offset:6656
ds_read_b64_tr_b16 v[24:25], v6 offset:6144
ds_read_b64_tr_b16 v[26:27], v6 offset:6656
s_waitcnt vmcnt(2) lgkmcnt(8)
v_mfma_f32_32x32x16_bf16 v[48:63], v[28:31], a[4:7], v[48:63]
v_mfma_f32_32x32x16_bf16 v[64:79], v[32:35], a[4:7], v[64:79]
ds_read_b64_tr_b16 v[28:29], v10 offset:0
ds_read_b64_tr_b16 v[30:31], v10 offset:512
ds_read_b64_tr_b16 v[32:33], v11 offset:0
ds_read_b64_tr_b16 v[34:35], v11 offset:512
s_waitcnt vmcnt(1) lgkmcnt(8)
v_mfma_f32_32x32x16_bf16 v[48:63], v[36:39], a[8:11], v[48:63]
v_mfma_f32_32x32x16_bf16 v[64:79], v[40:43], a[8:11], v[64:79]
ds_read_b64_tr_b16 v[36:37], v10 offset:2048
ds_read_b64_tr_b16 v[38:39], v10 offset:2560
ds_read_b64_tr_b16 v[40:41], v11 offset:2048
ds_read_b64_tr_b16 v[42:43], v11 offset:2560
s_waitcnt vmcnt(0) lgkmcnt(8)
v_mfma_f32_32x32x16_bf16 v[48:63], v[20:23], a[12:15], v[48:63]
v_mfma_f32_32x32x16_bf16 v[64:79], v[24:27], a[12:15], v[64:79]
s_cmp_eq_u32 s29, 0
s_cbranch_scc0 L_nopoll8
v_readfirstlane_b32 s57, v13
s_nop 3
s_cmp_ge_u32 s57, 8
s_cbranch_scc1 L_ok_cnt8
s_mov_b32 s56, 0
L_spin_cnt8:
global_load_dword v13, v12, s[24:25] sc1
s_waitcnt vmcnt(0)
v_readfirstlane_b32 s57, v13
s_add_u32 s56, s56, 1
s_cmp_ge_u32 s56, 0xf4240
s_cbranch_scc1 L_spun_cnt8
s_nop 0
s_cmp_lt_u32 s57, 8
s_cbranch_scc1 L_spin_cnt8
L_spun_cnt8:
L_ok_cnt8:
L_nopoll8:
s_barrier
s_lshl_b32 s52, s61, 12
s_add_u32 s52, s52, s60
s_add_u32 s61, s61, 1
s_and_b32 s61, s61, 7
buffer_load_dwordx4 a[16:19], v2, s[44:47], s52 offen offset:0 sc1
buffer_load_dwordx4 a[20:23], v2, s[44:47], s52 offen offset:1024 sc1
buffer_load_dwordx4 a[24:27], v2, s[44:47], s52 offen offset:2048 sc1
buffer_load_dwordx4 a[28:31], v2, s[44:47], s52 offen offset:3072 sc1
s_lshl_b32 s52, s61, 12
s_add_u32 s52, s52, s60
s_add_u32 s61, s61, 1
s_and_b32 s61, s61, 7
buffer_load_dwordx4 a[32:35], v2, s[44:47], s52 offen offset:0 sc1
buffer_load_dwordx4 a[36:39], v2, s[44:47], s52 offen offset:1024 sc1
buffer_load_dwordx4 a[40:43], v2, s[44:47], s52 offen offset:2048 sc1
buffer_load_dwordx4 a[44:47], v2, s[44:47], s52 offen offset:3072 sc1
s_add_u32 s62, s62, 8192
s_and_b32 s62, s62, 0xffff
v_add_u32 v5, s62, v3
v_xor_b32 v6, 64, v5
ds_read_b64_tr_b16 v[20:21], v10 offset:4096
ds_read_b64_tr_b16 v[22:23], v10 offset:4608
ds_read_b64_tr_b16 v[24:25], v11 offset:4096
ds_read_b64_tr_b16 v[26:27], v11 offset:4608
s_waitcnt vmcnt(7) lgkmcnt(8)
v_mfma_f32_32x32x16_bf16 v[48:63], v[28:31], a[16:19], v[48:63]
s_lshl_b32 s52, s61, 12
s_add_u32 s52, s52, s60
s_add_u32 s61, s61, 1
s_and_b32 s61, s61, 7
buffer_load_dwordx4 a[48:51], v2, s[44:47], s52 offen offset:0 sc1
v_mfma_f32_32x32x16_bf16 v[64:79], v[32:35], a[16:19], v[64:79]
ds_read_b64_tr_b16 v[28:29], v10 offset:6144
ds_read_b64_tr_b16 v[30:31], v10 offset:6656
ds_read_b64_tr_b16 v[32:33], v11 offset:6144
ds_read_b64_tr_b16 v[34:35], v11 offset:6656
s_waitcnt vmcnt(7) lgkmcnt(8)
v_mfma_f32_32x32x16_bf16 v[48:63], v[36:39], a[20:23], v[48:63]
buffer_load_dwordx4 a[52:55], v2, s[44:47], s52 offen offset:1024 sc1
v_mfma_f32_32x32x16_bf16 v[64:79], v[40:43], a[20:23], v[64:79]
ds_read_b64_tr_b16 v[36:37], v5 offset:0
ds_read_b64_tr_b16 v[38:39], v5 offset:512
ds_read_b64_tr_b16 v[40:41], v6 offset:0
ds_read_b64_tr_b16 v[42:43], v6 offset:512
s_waitcnt vmcnt(7) lgkmcnt(8)
v_mfma_f32_32x32x16_bf16 v[48:63], v[20:23], a[24:27], v[48:63]
buffer_load_dwordx4 a[56:59], v2, s[44:47], s52 offen offset:2048 sc1
v_mfma_f32_32x32x16_bf16 v[64:79], v[24:27], a[24:27], v[64:79]
ds_read_b64_tr_b16 v[20:21], v5 offset:2048
ds_read_b64_tr_b16 v[22:23], v5 offset:2560
ds_read_b64_tr_b16 v[24:25], v6 offset:2048
ds_read_b64_tr_b16 v[26:27], v6 offset:2560
s_waitcnt vmcnt(7) lgkmcnt(8)
v_mfma_f32_32x32x16_bf16 v[48:63], v[28:31], a[28:31], v[48:63]
buffer_load_dwordx4 a[60:63], v2, s[44:47], s52 offen offset:3072 sc1
v_mfma_f32_32x32x16_bf16 v[64:79], v[32:35], a[28:31], v[64:79]
s_add_u32 s62, s62, 8192
s_and_b32 s62, s62, 0xffff
v_add_u32 v10, s62, v3
v_xor_b32 v11, 64, v10
ds_read_b64_tr_b16 v[28:29], v5 offset:4096
ds_read_b64_tr_b16 v[30:31], v5 offset:4608
ds_read_b64_tr_b16 v[32:33], v6 offset:4096
ds_read_b64_tr_b16 v[34:35], v6 offset:4608
s_waitcnt vmcnt(7) lgkmcnt(8)
v_mfma_f32_32x32x16_bf16 v[48:63], v[36:39], a[32:35], v[48:63]
s_lshl_b32 s52, s61, 12
s_add_u32 s52, s52, s60
s_add_u32 s61, s61, 1
s_and_b32 s61, s61, 7
buffer_load_dwordx4 a[64:67], v2, s[44:47], s52 offen offset:0 sc1
v_mfma_f32_32x32x16_bf16 v[64:79], v[40:43], a[32:35], v[64:79]
ds_read_b64_tr_b16 v[36:37], v5 offset:6144
ds_read_b64_tr_b16 v[38:39], v5 offset:6656
ds_read_b64_tr_b16 v[40:41], v6 offset:6144
ds_read_b64_tr_b16 v[42:43], v6 offset:6656
s_waitcnt vmcnt(7) lgkmcnt(8)
v_mfma_f32_32x32x16_bf16 v[48:63], v[20:23], a[36:39], v[48:63]
buffer_load_dwordx4 a[68:71], v2, s[44:47], s52 offen offset:1024 sc1
v_mfma_f32_32x32x16_bf16 v[64:79], v[24:27], a[36:39], v[64:79]
ds_read_b64_tr_b16 v[20:21], v10 offset:0
ds_read_b64_tr_b16 v[22:23], v10 offset:512
ds_read_b64_tr_b16 v[24:25], v11 offset:0
ds_read_b64_tr_b16 v[26:27], v11 offset:512
s_waitcnt vmcnt(7) lgkmcnt(8)
v_mfma_f32_32x32x16_bf16 v[48:63], v[28:31], a[40:43], v[48:63]
buffer_load_dwordx4 a[72:75], v2, s[44:47], s52 offen offset:2048 sc1
v_mfma_f32_32x32x16_bf16 v[64:79], v[32:35], a[40:43], v[64:79]
ds_read_b64_tr_b16 v[28:29], v10 offset:2048
ds_read_b64_tr_b16 v[30:31], v10 offset:2560
ds_read_b64_tr_b16 v[32:33], v11 offset:2048
ds_read_b64_tr_b16 v[34:35], v11 offset:2560
s_waitcnt vmcnt(7) lgkmcnt(8)
v_mfma_f32_32x32x16_bf16 v[48:63], v[36:39], a[44:47], v[48:63]
buffer_load_dwordx4 a[76:79], v2, s[44:47], s52 offen offset:3072 sc1
v_mfma_f32_32x32x16_bf16 v[64:79], v[40:43], a[44:47], v[64:79]
s_add_u32 s62, s62, 8192
s_and_b32 s62, s62, 0xffff
v_add_u32 v5, s62, v3
v_xor_b32 v6, 64, v5
ds_read_b64_tr_b16 v[36:37], v10 offset:4096
ds_read_b64_tr_b16 v[38:39], v10 offset:4608
ds_read_b64_tr_b16 v[40:41], v11 offset:4096
ds_read_b64_tr_b16 v[42:43], v11 offset:4608
s_waitcnt vmcnt(7) lgkmcnt(8)
v_mfma_f32_32x32x16_bf16 v[48:63], v[20:23], a[48:51], v[48:63]
s_lshl_b32 s52, s61, 12
s_add_u32 s52, s52, s60
s_add_u32 s61, s61, 1
s_and_b32 s61, s61, 7
buffer_load_dwordx4 a[80:83], v2, s[44:47], s52 offen offset:0 sc1
v_mfma_f32_32x32x16_bf16 v[64:79], v[24:27], a[48:51], v[64:79]
ds_read_b64_tr_b16 v[20:21], v10 offset:6144
ds_read_b64_tr_b16 v[22:23], v10 offset:6656
ds_read_b64_tr_b16 v[24:25], v11 offset:6144
ds_read_b64_tr_b16 v[26:27], v11 offset:6656
s_waitcnt vmcnt(7) lgkmcnt(8)
v_mfma_f32_32x32x16_bf16 v[48:63], v[28:31], a[52:55], v[48:63]
buffer_load_dwordx4 a[84:87], v2, s[44:47], s52 offen offset:1024 sc1
v_mfma_f32_32x32x16_bf16 v[64:79], v[32:35], a[52:55], v[64:79]
ds_read_b64_tr_b16 v[28:29], v5 offset:0
ds_read_b64_tr_b16 v[30:31], v5 offset:512
ds_read_b64_tr_b16 v[32:33], v6 offset:0
ds_read_b64_tr_b16 v[34:35], v6 offset:512
s_waitcnt vmcnt(7) lgkmcnt(8)
v_mfma_f32_32x32x16_bf16 v[48:63], v[36:39], a[56:59], v[48:63]
buffer_load_dwordx4 a[88:91], v2, s[44:47], s52 offen offset:2048 sc1
v_mfma_f32_32x32x16_bf16 v[64:79], v[40:43], a[56:59], v[64:79]
ds_read_b64_tr_b16 v[36:37], v5 offset:2048
ds_read_b64_tr_b16 v[38:39], v5 offset:2560
ds_read_b64_tr_b16 v[40:41], v6 offset:2048
ds_read_b64_tr_b16 v[42:43], v6 offset:2560
s_waitcnt vmcnt(7) lgkmcnt(8)
v_mfma_f32_32x32x16_bf16 v[48:63], v[20:23], a[60:63], v[48:63]
buffer_load_dwordx4 a[92:95], v2, s[44:47], s52 offen offset:3072 sc1
v_mfma_f32_32x32x16_bf16 v[64:79], v[24:27], a[60:63], v[64:79]
s_add_u32 s62, s62, 8192
s_and_b32 s62, s62, 0xffff
v_add_u32 v10, s62, v3
v_xor_b32 v11, 64, v10
ds_read_b64_tr_b16 v[20:21], v5 offset:4096
ds_read_b64_tr_b16 v[22:23], v5 offset:4608
ds_read_b64_tr_b16 v[24:25], v6 offset:4096
ds_read_b64_tr_b16 v[26:27], v6 offset:4608
s_waitcnt vmcnt(7) lgkmcnt(8)
v_mfma_f32_32x32x16_bf16 v[48:63], v[28:31], a[64:67], v[48:63]
s_lshl_b32 s52, s61, 12
s_add_u32 s52, s52, s60
s_add_u32 s61, s61, 1
s_and_b32 s61, s61, 7
buffer_load_dwordx4 a[96:99], v2, s[44:47], s52 offen offset:0 sc1
v_mfma_f32_32x32x16_bf16 v[64:79], v[32:35], a[64:67], v[64:79]
ds_read_b64_tr_b16 v[28:29], v5 offset:6144
ds_read_b64_tr_b16 v[30:31], v5 offset:6656
ds_read_b64_tr_b16 v[32:33], v6 offset:6144
ds_read_b64_tr_b16 v[34:35], v6 offset:6656
s_waitcnt vmcnt(7) lgkmcnt(8)
v_mfma_f32_32x32x16_bf16 v[48:63], v[36:39], a[68:71], v[48:63]
buffer_load_dwordx4 a[100:103], v2, s[44:47], s52 offen offset:1024 sc1
v_mfma_f32_32x32x16_bf16 v[64:79], v[40:43], a[68:71], v[64:79]
ds_read_b64_tr_b16 v[36:37], v10 offset:0
ds_read_b64_tr_b16 v[38:39], v10 offset:512
ds_read_b64_tr_b16 v[40:41], v11 offset:0
ds_read_b64_tr_b16 v[42:43], v11 offset:512
s_waitcnt vmcnt(7) lgkmcnt(8)
v_mfma_f32_32x32x16_bf16 v[48:63], v[20:23], a[72:75], v[48:63]
buffer_load_dwordx4 a[104:107], v2, s[44:47], s52 offen offset:2048 sc1
v_mfma_f32_32x32x16_bf16 v[64:79], v[24:27], a[72:75], v[64:79]
ds_read_b64_tr_b16 v[20:21], v10 offset:2048
ds_read_b64_tr_b16 v[22:23], v10 offset:2560
ds_read_b64_tr_b16 v[24:25], v11 offset:2048
ds_read_b64_tr_b16 v[26:27], v11 offset:2560
s_waitcnt vmcnt(7) lgkmcnt(8)
v_mfma_f32_32x32x16_bf16 v[48:63], v[28:31], a[76:79], v[48:63]
buffer_load_dwordx4 a[108:111], v2, s[44:47], s52 offen offset:3072 sc1
v_mfma_f32_32x32x16_bf16 v[64:79], v[32:35], a[76:79], v[64:79]
s_add_u32 s62, s62, 8192
s_and_b32 s62, s62, 0xffff
v_add_u32 v5, s62, v3
v_xor_b32 v6, 64, v5
ds_read_b64_tr_b16 v[28:29], v10 offset:4096
ds_read_b64_tr_b16 v[30:31], v10 offset:4608
ds_read_b64_tr_b16 v[32:33], v11 offset:4096
ds_read_b64_tr_b16 v[34:35], v11 offset:4608
s_waitcnt vmcnt(7) lgkmcnt(8)
v_mfma_f32_32x32x16_bf16 v[48:63], v[36:39], a[80:83], v[48:63]
s_lshl_b32 s52, s61, 12
s_add_u32 s52, s52, s60
s_add_u32 s61, s61, 1
s_and_b32 s61, s61, 7
buffer_load_dwordx4 a[112:115], v2, s[44:47], s52 offen offset:0 sc1
v_mfma_f32_32x32x16_bf16 v[64:79], v[40:43], a[80:83], v[64:79]
ds_read_b64_tr_b16 v[36:37], v10 offset:6144
ds_read_b64_tr_b16 v[38:39], v10 offset:6656
ds_read_b64_tr_b16 v[40:41], v11 offset:6144
ds_read_b64_tr_b16 v[42:43], v11 offset:6656
s_waitcnt vmcnt(7) lgkmcnt(8)
v_mfma_f32_32x32x16_bf16 v[48:63], v[20:23], a[84:87], v[48:63]
buffer_load_dwordx4 a[116:119], v2, s[44:47], s52 offen offset:1024 sc1
v_mfma_f32_32x32x16_bf16 v[64:79], v[24:27], a[84:87], v[64:79]
ds_read_b64_tr_b16 v[20:21], v5 offset:0
ds_read_b64_tr_b16 v[22:23], v5 offset:512
ds_read_b64_tr_b16 v[24:25], v6 offset:0
ds_read_b64_tr_b16 v[26:27], v6 offset:512
s_waitcnt vmcnt(7) lgkmcnt(8)
v_mfma_f32_32x32x16_bf16 v[48:63], v[28:31], a[88:91], v[48:63]
buffer_load_dwordx4 a[120:123], v2, s[44:47], s52 offen offset:2048 sc1
v_mfma_f32_32x32x16_bf16 v[64:79], v[32:35], a[88:91], v[64:79]
ds_read_b64_tr_b16 v[28:29], v5 offset:2048
ds_read_b64_tr_b16 v[30:31], v5 offset:2560
ds_read_b64_tr_b16 v[32:33], v6 offset:2048
ds_read_b64_tr_b16 v[34:35], v6 offset:2560
s_waitcnt vmcnt(7) lgkmcnt(8)
v_mfma_f32_32x32x16_bf16 v[48:63], v[36:39], a[92:95], v[48:63]
buffer_load_dwordx4 a[124:127], v2, s[44:47], s52 offen offset:3072 sc1
v_mfma_f32_32x32x16_bf16 v[64:79], v[40:43], a[92:95], v[64:79]
s_add_u32 s62, s62, 8192
s_and_b32 s62, s62, 0xffff
v_add_u32 v10, s62, v3
v_xor_b32 v11, 64, v10
ds_read_b64_tr_b16 v[36:37], v5 offset:4096
ds_read_b64_tr_b16 v[38:39], v5 offset:4608
ds_read_b64_tr_b16 v[40:41], v6 offset:4096
ds_read_b64_tr_b16 v[42:43], v6 offset:4608
s_waitcnt vmcnt(7) lgkmcnt(8)
v_mfma_f32_32x32x16_bf16 v[48:63], v[20:23], a[96:99], v[48:63]
v_mfma_f32_32x32x16_bf16 v[64:79], v[24:27], a[96:99], v[64:79]
ds_read_b64_tr_b16 v[20:21], v5 offset:6144
ds_read_b64_tr_b16 v[22:23], v5 offset:6656
ds_read_b64_tr_b16 v[24:25], v6 offset:6144
ds_read_b64_tr_b16 v[26:27], v6 offset:6656
s_waitcnt vmcnt(6) lgkmcnt(8)
v_mfma_f32_32x32x16_bf16 v[48:63], v[28:31], a[100:103], v[48:63]
v_mfma_f32_32x32x16_bf16 v[64:79], v[32:35], a[100:103], v[64:79]
ds_read_b64_tr_b16 v[28:29], v10 offset:0
ds_read_b64_tr_b16 v[30:31], v10 offset:512
ds_read_b64_tr_b16 v[32:33], v11 offset:0
ds_read_b64_tr_b16 v[34:35], v11 offset:512
s_waitcnt vmcnt(5) lgkmcnt(8)
v_mfma_f32_32x32x16_bf16 v[48:63], v[36:39], a[104:107], v[48:63]
v_mfma_f32_32x32x16_bf16 v[64:79], v[40:43], a[104:107], v[64:79]
ds_read_b64_tr_b16 v[36:37], v10 offset:2048
ds_read_b64_tr_b16 v[38:39], v10 offset:2560
ds_read_b64_tr_b16 v[40:41], v11 offset:2048
ds_read_b64_tr_b16 v[42:43], v11 offset:2560
s_waitcnt vmcnt(4) lgkmcnt(8)
v_mfma_f32_32x32x16_bf16 v[48:63], v[20:23], a[108:111], v[48:63]
v_mfma_f32_32x32x16_bf16 v[64:79], v[24:27], a[108:111], v[64:79]
ds_read_b64_tr_b16 v[20:21], v10 offset:4096
ds_read_b64_tr_b16 v[22:23], v10 offset:4608
ds_read_b64_tr_b16 v[24:25], v11 offset:4096
ds_read_b64_tr_b16 v[26:27], v11 offset:4608
s_waitcnt vmcnt(3) lgkmcnt(8)
v_mfma_f32_32x32x16_bf16 v[48:63], v[28:31], a[112:115], v[48:63]
v_mfma_f32_32x32x16_bf16 v[64:79], v[32:35], a[112:115], v[64:79]
ds_read_b64_tr_b16 v[28:29], v10 offset:6144
ds_read_b64_tr_b16 v[30:31], v10 offset:6656
ds_read_b64_tr_b16 v[32:33], v11 offset:6144
ds_read_b64_tr_b16 v[34:35], v11 offset:6656
s_waitcnt vmcnt(2) lgkmcnt(8)
v_mfma_f32_32x32x16_bf16 v[48:63], v[36:39], a[116:119], v[48:63]
v_mfma_f32_32x32x16_bf16 v[64:79], v[40:43], a[116:119], v[64:79]
s_waitcnt vmcnt(1) lgkmcnt(4)
v_mfma_f32_32x32x16_bf16 v[48:63], v[20:23], a[120:123], v[48:63]
v_mfma_f32_32x32x16_bf16 v[64:79], v[24:27], a[120:123], v[64:79]
s_waitcnt vmcnt(0) lgkmcnt(0)
v_mfma_f32_32x32x16_bf16 v[48:63], v[28:31], a[124:127], v[48:63]
v_mfma_f32_32x32x16_bf16 v[64:79], v[32:35], a[124:127], v[64:79]
s_nop 10
v_cvt_pk_bf16_f32 v84, v48, v49
v_cvt_pk_bf16_f32 v85, v50, v51
ds_write_b64 v116, v[84:85]
v_cvt_pk_bf16_f32 v86, v52, v53
v_cvt_pk_bf16_f32 v87, v54, v55
ds_write_b64 v117, v[86:87]
v_cvt_pk_bf16_f32 v88, v56, v57
v_cvt_pk_bf16_f32 v89, v58, v59
ds_write_b64 v118, v[88:89]
v_cvt_pk_bf16_f32 v90, v60, v61
v_cvt_pk_bf16_f32 v91, v62, v63
ds_write_b64 v119, v[90:91]
v_cvt_pk_bf16_f32 v92, v64, v65
v_cvt_pk_bf16_f32 v93, v66, v67
ds_write_b64 v120, v[92:93]
v_cvt_pk_bf16_f32 v94, v68, v69
v_cvt_pk_bf16_f32 v95, v70, v71
ds_write_b64 v121, v[94:95]
v_cvt_pk_bf16_f32 v96, v72, v73
v_cvt_pk_bf16_f32 v97, v74, v75
ds_write_b64 v122, v[96:97]
v_cvt_pk_bf16_f32 v98, v76, v77
v_cvt_pk_bf16_f32 v99, v78, v79
ds_write_b64 v123, v[98:99]
s_waitcnt lgkmcnt(0)
ds_read_b128 v[100:103], v124 offset:0
ds_read_b128 v[104:107], v124 offset:1024
ds_read_b128 v[108:111], v124 offset:2048
ds_read_b128 v[112:115], v124 offset:3072
s_waitcnt lgkmcnt(3)
buffer_store_dwordx4 v[100:103], v125, s[48:51], s74 offen sc0 sc1
s_add_u32 s74, s74, s63
s_waitcnt lgkmcnt(2)
buffer_store_dwordx4 v[104:107], v125, s[48:51], s74 offen sc0 sc1
s_add_u32 s74, s74, s63
s_waitcnt lgkmcnt(1)
buffer_store_dwordx4 v[108:111], v125, s[48:51], s74 offen sc0 sc1
s_add_u32 s74, s74, s63
s_waitcnt lgkmcnt(0)
buffer_store_dwordx4 v[112:115], v125, s[48:51], s74 offen sc0 sc1
s_endpgm
L_kend:
.section .rodata,"a"
.p2align 6
.amdhsa_kernel concat_heads__linear_attn_block__sliding_local_dilated__prompt_kernel
  .amdhsa_next_free_vgpr 512
  .amdhsa_next_free_sgpr 102
  .amdhsa_accum_offset 256
  .amdhsa_group_segment_fixed_size 0
  .amdhsa_kernarg_size 72
  .amdhsa_user_sgpr_count 2
  .amdhsa_user_sgpr_kernarg_segment_ptr 1
  .amdhsa_system_sgpr_workgroup_id_x 1
  .amdhsa_float_denorm_mode_32 3
.end_amdhsa_kernel
```
